```python
import torch

def _softmax(x, axis=-1):
    return torch.softmax(x, dim=axis)
def _gelu(x):
    return torch.nn.functional.gelu(x, approximate="tanh")
def _silu(x):
    return torch.nn.functional.silu(x)
def _sigmoid(x):
    return torch.sigmoid(x)
def _layernorm(x, axis=-1, eps=1e-5):
    m = x.mean(dim=axis, keepdim=True)
    v = x.var(dim=axis, keepdim=True, unbiased=False)
    return (x - m) / torch.sqrt(v + eps)
def _scatter_add(tgt, idx, src, axis=0):
    return tgt.clone().index_add_(axis, idx, src)
def _segment_sum(src, seg, n):
    out = torch.zeros((n,) + src.shape[1:], dtype=src.dtype)
    return out.index_add_(0, seg, src)
def _pad(x, pw):
    flat = tuple(v for pair in reversed(pw) for v in pair)
    return torch.nn.functional.pad(x, flat)

kernel_name = 'gated_mix__sliding_block_cached__gqa_block_cached__decode'

def setup_inputs():

    _w = (lambda a: (lambda t: t.to(torch.bfloat16) if t.is_floating_point() else t)(torch.as_tensor(a)))
    def _A_setup():
        B, Sq, D = 1, 1, 640
        Hq, Hkv, Sk, Dh = 32, 32, 4096, 192
        assert Hq % Hkv == 0, (Hq, Hkv)
        return {
            "x": _w((lambda *s: torch.randn(*s, dtype=torch.bfloat16) * 0.05)(B, Sq, D)),
            "k_cache": _w((lambda *s: torch.randn(*s, dtype=torch.bfloat16) * 6.4)(B, Hkv, Sk, Dh)),
            "v_cache": _w((lambda *s: torch.randn(*s, dtype=torch.bfloat16) * 0.05)(B, Hkv, Sk, Dh)),
            "wq": _w((lambda *s: torch.randn(*s, dtype=torch.bfloat16) * 6.4)(D, Hq * Dh) * (D ** -0.5)),
            "wo": _w((lambda *s: torch.randn(*s, dtype=torch.bfloat16) * 0.05)(Hq * Dh, D) * ((Hq * Dh) ** -0.5)),
        }
    _A_in = _A_setup()

    def _B_setup():
        B, Sq, D = 1, 1, 640
        Hq, Hkv, Sk, Dh = 32, 32, 4096, 192
        assert Hq % Hkv == 0, (Hq, Hkv)
        return {
            "x": _w((lambda *s: torch.randn(*s, dtype=torch.bfloat16) * 0.05)(B, Sq, D)),
            "k_cache": _w((lambda *s: torch.randn(*s, dtype=torch.bfloat16) * 6.4)(B, Hkv, Sk, Dh)),
            "v_cache": _w((lambda *s: torch.randn(*s, dtype=torch.bfloat16) * 0.05)(B, Hkv, Sk, Dh)),
            "wq": _w((lambda *s: torch.randn(*s, dtype=torch.bfloat16) * 6.4)(D, Hq * Dh) * (D ** -0.5)),
            "wo": _w((lambda *s: torch.randn(*s, dtype=torch.bfloat16) * 0.05)(Hq * Dh, D) * ((Hq * Dh) ** -0.5)),
        }
    _B_in = _B_setup()

    return {
        "A_x": _A_in["x"],
        "A_k_cache": _A_in["k_cache"],
        "A_v_cache": _A_in["v_cache"],
        "A_wq": _A_in["wq"],
        "A_wo": _A_in["wo"],
        "B_x": _B_in["x"],
        "B_k_cache": _B_in["k_cache"],
        "B_v_cache": _B_in["v_cache"],
        "B_wq": _B_in["wq"],
        "B_wo": _B_in["wo"],
        "gate_w": _w((lambda *s: torch.randn(*s, dtype=torch.bfloat16) * 0.05)(640) * 16.0),
    }

def reference(A_x, A_k_cache, A_v_cache, A_wq, A_wo, B_x, B_k_cache, B_v_cache, B_wq, B_wo, gate_w):
    def _A_ref(x, k_cache, v_cache, wq, wo):
        B, Sq, D = x.shape
        Hq, Dh = 32, 192
        Hkv, Sk = k_cache.shape[1], k_cache.shape[2]
        W = min(4096, max(256, Sk // 4))
        rep = Hq // Hkv
        q = (lambda x, *d: x.permute(*d))((x @ wq).reshape(B, Sq, Hq, Dh), 0, 2, 1, 3)
        k = (lambda x, n, axis: torch.repeat_interleave(x, n, dim=axis))(k_cache[:, :, Sk - W:, :], rep, axis=1)
        v = (lambda x, n, axis: torch.repeat_interleave(x, n, dim=axis))(v_cache[:, :, Sk - W:, :], rep, axis=1)
        scores = torch.einsum("bhqd,bhkd->bhqk", q, k) * (Dh ** -0.5)
        p = _softmax(scores, axis=-1)
        o = torch.einsum("bhqk,bhkd->bhqd", p, v)
        return (lambda x, *d: x.permute(*d))(o, 0, 2, 1, 3).reshape(B, Sq, Hq * Dh) @ wo

    def _B_ref(x, k_cache, v_cache, wq, wo):
        B, Sq, D = x.shape
        Hq, Dh = 32, 192
        Hkv = k_cache.shape[1]
        rep = Hq // Hkv
        q = (lambda x, *d: x.permute(*d))((x @ wq).reshape(B, Sq, Hq, Dh), 0, 2, 1, 3)
        k = (lambda x, n, axis: torch.repeat_interleave(x, n, dim=axis))(k_cache, rep, axis=1)
        v = (lambda x, n, axis: torch.repeat_interleave(x, n, dim=axis))(v_cache, rep, axis=1)
        scores = torch.einsum("bhqd,bhkd->bhqk", q, k) * (Dh ** -0.5)
        p = _softmax(scores, axis=-1)
        o = torch.einsum("bhqk,bhkd->bhqd", p, v)
        return (lambda x, *d: x.permute(*d))(o, 0, 2, 1, 3).reshape(B, Sq, Hq * Dh) @ wo

    x = A_x
    g = _sigmoid((x * gate_w).sum(-1, keepdims=True))
    a = _A_ref(x, A_k_cache, A_v_cache, A_wq, A_wo)
    b = _B_ref(x, B_k_cache, B_v_cache, B_wq, B_wo)
    return g * a + (1 - g) * b
```

```asm
; @launch grid=(256,1,1) block=(384,1,1) lds=12288
.amdgcn_target "amdgcn-amd-amdhsa--gfx950"
.text
.globl gated_mix__sliding_block_cached__gqa_block_cached__decode_kernel
.p2align 12
.p2align 8
.type gated_mix__sliding_block_cached__gqa_block_cached__decode_kernel,@function
gated_mix__sliding_block_cached__gqa_block_cached__decode_kernel:
s_cmp_ge_u32 s2, 256
s_cbranch_scc1 L_end
s_load_dwordx16 s[4:19], s[0:1], 0
s_load_dwordx8 s[20:27], s[0:1], 64
s_load_dwordx4 s[28:31], s[0:1], 96
v_lshrrev_b32 v1, 6, v0
v_and_b32 v0, 63, v0
s_lshr_b32 s34, s2, 3
v_readfirstlane_b32 s33, v1
s_and_b32 s35, s2, 7
s_and_b32 s36, s35, 1
s_lshr_b32 s37, s35, 1
s_and_b32 s37, s37, 1
s_lshr_b32 s38, s35, 2
s_cmp_lg_u32 s33, 5
s_cbranch_scc1 L_streamer
s_setprio 3
v_and_b32 v7, 7, v0
v_lshrrev_b32 v6, 3, v0
v_lshlrev_b32 v34, 2, v0
v_add_u32 v34, 11328, v34
v_subrev_u32 v33, 5, v0
v_cmp_gt_u32 vcc, 3, v33
s_nop 1
v_cndmask_b32_e64 v32, 0, 64, vcc
s_mov_b32 exec_lo, 0xffffff
s_mov_b32 exec_hi, 0
ds_write_b32 v34, v32
s_mov_b64 exec, -1
v_lshlrev_b32 v2, 2, v7
v_add_u32 v2, 11328, v2
s_waitcnt lgkmcnt(0)
s_load_dword s32, s[30:31], 0
s_barrier
s_branch L_agent
L_streamer:
v_lshrrev_b32 v94, 3, v0
v_and_b32 v95, 7, v0
s_and_b32 s39, s35, 3
s_mul_i32 s39, s39, 160
s_lshl_b32 s76, s33, 5
s_add_u32 s39, s39, s76
v_lshlrev_b32 v88, 2, v94
v_add_u32 v88, s39, v88
v_lshlrev_b32 v89, 1, v88
v_mul_u32_u24 v3, 0x3000, v88
v_lshlrev_b32 v90, 4, v95
s_mul_i32 s76, s34, 384
v_add_u32 v3, v3, v90
v_add_u32 v3, s76, v3
s_lshl_b32 s76, s35, 2
s_add_u32 s76, s76, s33
s_sub_u32 s76, s76, 1
s_add_u32 s39, s35, 384
s_mov_b32 s78, 98304
s_cmp_eq_u32 s33, 0
s_cselect_b32 s39, s39, s76
s_cselect_b32 s78, 24576, s78
s_mul_i32 s39, s39, 3072
s_mul_i32 s76, s34, 1572864
v_mul_u32_u24 v2, 384, v94
v_add_u32 v2, v2, v90
v_add_u32 v2, s76, v2
v_add_u32 v1, s39, v2
s_waitcnt lgkmcnt(0)
s_load_dword s32, s[30:31], 0
s_mov_b32 s56, s4
s_and_b32 s57, s5, 0xffff
s_mov_b32 s58, 1280
s_mov_b32 s59, 0x20000
s_cmp_eq_u32 s38, 0
s_cselect_b32 s10, s10, s20
s_cselect_b32 s11, s11, s21
s_cselect_b32 s12, s12, s22
s_cselect_b32 s13, s13, s23
s_mov_b32 s40, s10
s_and_b32 s41, s11, 0xffff
s_mov_b32 s42, 7864320
s_mov_b32 s43, 0x20000
buffer_load_dwordx2 v[12:13], v89, s[56:59], 0 offen
buffer_load_dwordx4 v[112:115], v3, s[40:43], 0 offen offset:0 nt
buffer_load_dwordx4 v[116:119], v3, s[40:43], 0 offen offset:128 nt
buffer_load_dwordx4 v[120:123], v3, s[40:43], 0 offen offset:256 nt
v_add_u32 v3, 0x3000, v3
buffer_load_dwordx4 v[124:127], v3, s[40:43], 0 offen offset:0 nt
buffer_load_dwordx4 v[128:131], v3, s[40:43], 0 offen offset:128 nt
buffer_load_dwordx4 v[132:135], v3, s[40:43], 0 offen offset:256 nt
v_add_u32 v3, 0x3000, v3
buffer_load_dwordx4 v[136:139], v3, s[40:43], 0 offen offset:0 nt
buffer_load_dwordx4 v[140:143], v3, s[40:43], 0 offen offset:128 nt
buffer_load_dwordx4 v[144:147], v3, s[40:43], 0 offen offset:256 nt
v_add_u32 v3, 0x3000, v3
buffer_load_dwordx4 v[148:151], v3, s[40:43], 0 offen offset:0 nt
buffer_load_dwordx4 v[152:155], v3, s[40:43], 0 offen offset:128 nt
buffer_load_dwordx4 v[156:159], v3, s[40:43], 0 offen offset:256 nt
s_cmp_eq_u32 s33, 0
s_cselect_b32 s6, s6, s16
s_cselect_b32 s7, s7, s17
s_cselect_b32 s8, s8, s18
s_cselect_b32 s9, s9, s19
s_cselect_b32 s39, 0, 1
s_mov_b32 s44, s6
s_and_b32 s45, s7, 0xffff
s_mov_b32 s46, 50331648
s_mov_b32 s47, 0x20000
s_mov_b32 s48, s8
s_and_b32 s49, s9, 0xffff
s_mov_b32 s50, 50331648
s_mov_b32 s51, 0x20000
s_mov_b32 s52, s12
s_and_b32 s53, s13, 0xffff
s_mov_b32 s54, 7864320
s_mov_b32 s55, 0x20000
s_mov_b32 s60, s30
s_and_b32 s61, s31, 0xffff
s_mov_b32 s62, 1474560
s_mov_b32 s63, 0x20000
s_mul_i32 s39, s39, 384
s_add_u32 s39, s39, 10240
v_mul_u32_u24 v7, 48, v95
v_add_u32 v7, s39, v7
s_lshl_b32 s39, s33, 10
v_lshlrev_b32 v6, 4, v0
v_add_u32 v6, s39, v6
v_lshlrev_b32 v8, 5, v94
v_add_u32 v8, 11008, v8
s_lshl_b32 s39, s33, 3
s_add_u32 s39, s39, 11264
v_mov_b32 v9, s39
s_lshl_b32 s39, s33, 2
s_add_u32 s39, s39, 11328
v_mov_b32 v10, s39
s_mul_i32 s39, s34, 245760
s_mul_i32 s76, s36, 640
s_add_u32 s39, s39, s76
s_lshl_b32 s76, s33, 7
s_add_u32 s39, s39, s76
v_mul_u32_u24 v4, 0x2800, v94
v_lshlrev_b32 v90, 4, v95
v_add_u32 v4, v4, v90
v_add_u32 v4, s39, v4
s_cmp_eq_u32 s37, 0
s_mov_b32 s64, 87040
s_cselect_b32 s64, 0, s64
s_mov_b32 s65, 88320
s_cselect_b32 s65, 1280, s65
s_mov_b32 s66, 89600
s_cselect_b32 s66, 2560, s66
s_mov_b32 s67, 90880
s_cselect_b32 s67, 3840, s67
s_mov_b32 s68, 163840
s_cselect_b32 s68, 5120, s68
s_mov_b32 s69, 165120
s_cselect_b32 s69, 6400, s69
s_mov_b32 s70, 166400
s_cselect_b32 s70, 7680, s70
s_mov_b32 s71, 167680
s_cselect_b32 s71, 8960, s71
s_mov_b32 s72, 168960
s_cselect_b32 s72, 81920, s72
s_mov_b32 s73, 170240
s_cselect_b32 s73, 83200, s73
s_mov_b32 s74, 171520
s_cselect_b32 s74, 84480, s74
s_mov_b32 s75, 172800
s_cselect_b32 s75, 85760, s75
s_lshl_b32 s39, s38, 6
s_lshl_b32 s76, s34, 1
s_add_u32 s39, s39, s76
s_add_u32 s39, s39, s37
s_mul_i32 s39, s39, 2560
s_mul_i32 s76, s36, 1280
s_add_u32 s39, s39, s76
s_lshl_b32 s76, s33, 8
s_add_u32 s39, s39, s76
s_add_u32 s39, s39, 802816
v_lshlrev_b32 v5, 5, v95
v_lshrrev_b32 v90, 5, v0
v_lshlrev_b32 v90, 4, v90
v_add_u32 v5, v5, v90
v_add_u32 v5, s39, v5
s_mov_b32 s80, 0x3d93cd3a
s_mov_b32 s81, 0x3fb8aa3b
s_mov_b32 s82, 0x05040100
s_mov_b32 s83, 0x07060302
s_mov_b32 s84, 0x7060500
s_mov_b32 s85, 0x7060501
s_mov_b32 s86, 0x7060502
s_mov_b32 s87, 0x7060503
v_mov_b32 v16, 0
v_mov_b32 v17, 0
v_mov_b32 v18, 0
v_mov_b32 v19, 0
v_mov_b32 v20, 0
v_mov_b32 v21, 0
v_mov_b32 v22, 0
v_mov_b32 v23, 0
v_mov_b32 v24, 0
v_mov_b32 v25, 0
v_mov_b32 v26, 0
v_mov_b32 v27, 0
v_mov_b32 v28, 0
v_mov_b32 v29, 0
v_mov_b32 v30, 0
v_mov_b32 v31, 0
v_mov_b32 v32, 0
v_mov_b32 v33, 0
v_mov_b32 v34, 0
v_mov_b32 v35, 0
v_mov_b32 v36, 0
v_mov_b32 v37, 0
v_mov_b32 v38, 0
v_mov_b32 v39, 0
v_mov_b32 v104, 0
v_mov_b32 v105, 0
v_mov_b32 v106, 0
v_mov_b32 v107, 0
v_mov_b32 v108, 0
v_mov_b32 v109, 0
v_mov_b32 v110, 0
v_mov_b32 v111, 0
v_mov_b32 v52, 0
v_mov_b32 v57, 0
v_mov_b32 v56, 0xff800000
v_mov_b32 v58, 0xff800000
s_barrier
s_waitcnt vmcnt(12)
s_waitcnt vmcnt(9)
buffer_load_dwordx4 v[160:163], v1, s[44:47], 0 offen offset:0 nt
buffer_load_dwordx4 v[164:167], v1, s[44:47], 0 offen offset:128 nt
buffer_load_dwordx4 v[168:171], v1, s[44:47], 0 offen offset:256 nt
v_and_b32 v14, 0xffff, v12
v_lshlrev_b32 v15, 16, v12
v_dot2c_f32_bf16 v16, v112, v14
v_dot2c_f32_bf16 v17, v112, v15
v_dot2c_f32_bf16 v18, v113, v14
v_dot2c_f32_bf16 v19, v113, v15
v_dot2c_f32_bf16 v20, v114, v14
v_dot2c_f32_bf16 v21, v114, v15
v_dot2c_f32_bf16 v22, v115, v14
v_dot2c_f32_bf16 v23, v115, v15
v_dot2c_f32_bf16 v24, v116, v14
v_dot2c_f32_bf16 v25, v116, v15
v_dot2c_f32_bf16 v26, v117, v14
v_dot2c_f32_bf16 v27, v117, v15
v_dot2c_f32_bf16 v28, v118, v14
v_dot2c_f32_bf16 v29, v118, v15
v_dot2c_f32_bf16 v30, v119, v14
v_dot2c_f32_bf16 v31, v119, v15
v_dot2c_f32_bf16 v32, v120, v14
v_dot2c_f32_bf16 v33, v120, v15
v_dot2c_f32_bf16 v34, v121, v14
v_dot2c_f32_bf16 v35, v121, v15
v_dot2c_f32_bf16 v36, v122, v14
v_dot2c_f32_bf16 v37, v122, v15
v_dot2c_f32_bf16 v38, v123, v14
v_dot2c_f32_bf16 v39, v123, v15
s_waitcnt vmcnt(9)
buffer_load_dwordx4 v[172:175], v1, s[48:51], 0 offen offset:0 nt
buffer_load_dwordx4 v[176:179], v1, s[48:51], 0 offen offset:128 nt
buffer_load_dwordx4 v[180:183], v1, s[48:51], 0 offen offset:256 nt
v_add_u32 v1, s78, v1
v_lshrrev_b32 v14, 16, v12
v_and_b32 v15, 0xffff0000, v12
v_dot2c_f32_bf16 v16, v124, v14
v_dot2c_f32_bf16 v17, v124, v15
v_dot2c_f32_bf16 v18, v125, v14
v_dot2c_f32_bf16 v19, v125, v15
v_dot2c_f32_bf16 v20, v126, v14
v_dot2c_f32_bf16 v21, v126, v15
v_dot2c_f32_bf16 v22, v127, v14
v_dot2c_f32_bf16 v23, v127, v15
v_dot2c_f32_bf16 v24, v128, v14
v_dot2c_f32_bf16 v25, v128, v15
v_dot2c_f32_bf16 v26, v129, v14
v_dot2c_f32_bf16 v27, v129, v15
v_dot2c_f32_bf16 v28, v130, v14
v_dot2c_f32_bf16 v29, v130, v15
v_dot2c_f32_bf16 v30, v131, v14
v_dot2c_f32_bf16 v31, v131, v15
v_dot2c_f32_bf16 v32, v132, v14
v_dot2c_f32_bf16 v33, v132, v15
v_dot2c_f32_bf16 v34, v133, v14
v_dot2c_f32_bf16 v35, v133, v15
v_dot2c_f32_bf16 v36, v134, v14
v_dot2c_f32_bf16 v37, v134, v15
v_dot2c_f32_bf16 v38, v135, v14
v_dot2c_f32_bf16 v39, v135, v15
s_waitcnt vmcnt(9)
buffer_load_dwordx4 v[184:187], v1, s[44:47], 0 offen offset:0 nt
buffer_load_dwordx4 v[188:191], v1, s[44:47], 0 offen offset:128 nt
buffer_load_dwordx4 v[192:195], v1, s[44:47], 0 offen offset:256 nt
v_and_b32 v14, 0xffff, v13
v_lshlrev_b32 v15, 16, v13
v_dot2c_f32_bf16 v16, v136, v14
v_dot2c_f32_bf16 v17, v136, v15
v_dot2c_f32_bf16 v18, v137, v14
v_dot2c_f32_bf16 v19, v137, v15
v_dot2c_f32_bf16 v20, v138, v14
v_dot2c_f32_bf16 v21, v138, v15
v_dot2c_f32_bf16 v22, v139, v14
v_dot2c_f32_bf16 v23, v139, v15
v_dot2c_f32_bf16 v24, v140, v14
v_dot2c_f32_bf16 v25, v140, v15
v_dot2c_f32_bf16 v26, v141, v14
v_dot2c_f32_bf16 v27, v141, v15
v_dot2c_f32_bf16 v28, v142, v14
v_dot2c_f32_bf16 v29, v142, v15
v_dot2c_f32_bf16 v30, v143, v14
v_dot2c_f32_bf16 v31, v143, v15
v_dot2c_f32_bf16 v32, v144, v14
v_dot2c_f32_bf16 v33, v144, v15
v_dot2c_f32_bf16 v34, v145, v14
v_dot2c_f32_bf16 v35, v145, v15
v_dot2c_f32_bf16 v36, v146, v14
v_dot2c_f32_bf16 v37, v146, v15
v_dot2c_f32_bf16 v38, v147, v14
v_dot2c_f32_bf16 v39, v147, v15
s_waitcnt vmcnt(9)
buffer_load_dwordx4 v[196:199], v1, s[48:51], 0 offen offset:0 nt
buffer_load_dwordx4 v[200:203], v1, s[48:51], 0 offen offset:128 nt
buffer_load_dwordx4 v[204:207], v1, s[48:51], 0 offen offset:256 nt
v_add_u32 v1, s78, v1
v_lshrrev_b32 v14, 16, v13
v_and_b32 v15, 0xffff0000, v13
v_dot2c_f32_bf16 v16, v148, v14
v_dot2c_f32_bf16 v17, v148, v15
v_dot2c_f32_bf16 v18, v149, v14
v_dot2c_f32_bf16 v19, v149, v15
v_dot2c_f32_bf16 v20, v150, v14
v_dot2c_f32_bf16 v21, v150, v15
v_dot2c_f32_bf16 v22, v151, v14
v_dot2c_f32_bf16 v23, v151, v15
v_dot2c_f32_bf16 v24, v152, v14
v_dot2c_f32_bf16 v25, v152, v15
v_dot2c_f32_bf16 v26, v153, v14
v_dot2c_f32_bf16 v27, v153, v15
v_dot2c_f32_bf16 v28, v154, v14
v_dot2c_f32_bf16 v29, v154, v15
v_dot2c_f32_bf16 v30, v155, v14
v_dot2c_f32_bf16 v31, v155, v15
v_dot2c_f32_bf16 v32, v156, v14
v_dot2c_f32_bf16 v33, v156, v15
v_dot2c_f32_bf16 v34, v157, v14
v_dot2c_f32_bf16 v35, v157, v15
v_dot2c_f32_bf16 v36, v158, v14
v_dot2c_f32_bf16 v37, v158, v15
v_dot2c_f32_bf16 v38, v159, v14
v_dot2c_f32_bf16 v39, v159, v15
v_permlane32_swap_b32 v16, v28
v_permlane32_swap_b32 v17, v29
v_permlane32_swap_b32 v18, v30
v_permlane32_swap_b32 v19, v31
v_permlane32_swap_b32 v20, v32
v_permlane32_swap_b32 v21, v33
v_permlane32_swap_b32 v22, v34
v_permlane32_swap_b32 v23, v35
v_permlane32_swap_b32 v24, v36
v_permlane32_swap_b32 v25, v37
v_permlane32_swap_b32 v26, v38
v_permlane32_swap_b32 v27, v39
v_add_f32 v16, v16, v28
v_add_f32 v17, v17, v29
v_add_f32 v18, v18, v30
v_add_f32 v19, v19, v31
v_add_f32 v20, v20, v32
v_add_f32 v21, v21, v33
v_add_f32 v22, v22, v34
v_add_f32 v23, v23, v35
v_add_f32 v24, v24, v36
v_add_f32 v25, v25, v37
v_add_f32 v26, v26, v38
v_add_f32 v27, v27, v39
v_permlane16_swap_b32 v16, v22
v_permlane16_swap_b32 v17, v23
v_permlane16_swap_b32 v18, v24
v_permlane16_swap_b32 v19, v25
v_permlane16_swap_b32 v20, v26
v_permlane16_swap_b32 v21, v27
v_add_f32 v16, v16, v22
v_add_f32 v17, v17, v23
v_add_f32 v18, v18, v24
v_add_f32 v19, v19, v25
v_add_f32 v20, v20, v26
v_add_f32 v21, v21, v27
v_add_f32_dpp v16, v16, v16 row_ror:8 row_mask:0xf bank_mask:0x3
v_add_f32_dpp v17, v17, v17 row_ror:8 row_mask:0xf bank_mask:0x3
v_add_f32_dpp v18, v18, v18 row_ror:8 row_mask:0xf bank_mask:0x3
v_add_f32_dpp v16, v19, v19 row_ror:8 row_mask:0xf bank_mask:0xc
v_add_f32_dpp v17, v20, v20 row_ror:8 row_mask:0xf bank_mask:0xc
v_add_f32_dpp v18, v21, v21 row_ror:8 row_mask:0xf bank_mask:0xc
ds_write_b96 v6, v[16:18] offset:0
s_waitcnt lgkmcnt(0)
v_mov_b32 v95, 1
s_mov_b64 exec, 1
ds_write_b32 v10, v95
s_mov_b64 exec, -1
v_mov_b32 v16, 0
v_mov_b32 v17, 0
v_mov_b32 v18, 0
v_mov_b32 v19, 0
v_mov_b32 v20, 0
v_mov_b32 v21, 0
v_mov_b32 v22, 0
v_mov_b32 v23, 0
v_mov_b32 v24, 0
v_mov_b32 v25, 0
v_mov_b32 v26, 0
v_mov_b32 v27, 0
v_mov_b32 v28, 0
v_mov_b32 v29, 0
v_mov_b32 v30, 0
v_mov_b32 v31, 0
v_mov_b32 v32, 0
v_mov_b32 v33, 0
v_mov_b32 v34, 0
v_mov_b32 v35, 0
v_mov_b32 v36, 0
v_mov_b32 v37, 0
v_mov_b32 v38, 0
v_mov_b32 v39, 0
s_waitcnt vmcnt(9)
buffer_load_dwordx4 v[208:211], v1, s[44:47], 0 offen offset:0 nt
buffer_load_dwordx4 v[212:215], v1, s[44:47], 0 offen offset:128 nt
buffer_load_dwordx4 v[216:219], v1, s[44:47], 0 offen offset:256 nt
s_waitcnt vmcnt(9)
buffer_load_dwordx4 v[220:223], v1, s[48:51], 0 offen offset:0 nt
buffer_load_dwordx4 v[224:227], v1, s[48:51], 0 offen offset:128 nt
buffer_load_dwordx4 v[228:231], v1, s[48:51], 0 offen offset:256 nt
v_add_u32 v1, s78, v1
s_waitcnt vmcnt(9)
buffer_load_dwordx4 v[232:235], v1, s[44:47], 0 offen offset:0 nt
buffer_load_dwordx4 v[236:239], v1, s[44:47], 0 offen offset:128 nt
buffer_load_dwordx4 v[240:243], v1, s[44:47], 0 offen offset:256 nt
s_waitcnt vmcnt(9)
buffer_load_dwordx4 v[244:247], v1, s[48:51], 0 offen offset:0 nt
buffer_load_dwordx4 v[248:251], v1, s[48:51], 0 offen offset:128 nt
buffer_load_dwordx4 v[252:255], v1, s[48:51], 0 offen offset:256 nt
v_add_u32 v1, s78, v1
s_waitcnt vmcnt(9)
buffer_load_dwordx4 v[112:115], v1, s[44:47], 0 offen offset:0 nt
buffer_load_dwordx4 v[116:119], v1, s[44:47], 0 offen offset:128 nt
buffer_load_dwordx4 v[120:123], v1, s[44:47], 0 offen offset:256 nt
s_waitcnt vmcnt(9)
buffer_load_dwordx4 v[124:127], v1, s[48:51], 0 offen offset:0 nt
buffer_load_dwordx4 v[128:131], v1, s[48:51], 0 offen offset:128 nt
buffer_load_dwordx4 v[132:135], v1, s[48:51], 0 offen offset:256 nt
v_add_u32 v1, s78, v1
s_waitcnt vmcnt(9)
buffer_load_dwordx4 v[136:139], v1, s[44:47], 0 offen offset:0 nt
buffer_load_dwordx4 v[140:143], v1, s[44:47], 0 offen offset:128 nt
buffer_load_dwordx4 v[144:147], v1, s[44:47], 0 offen offset:256 nt
s_waitcnt vmcnt(9)
buffer_load_dwordx4 v[148:151], v1, s[48:51], 0 offen offset:0 nt
buffer_load_dwordx4 v[152:155], v1, s[48:51], 0 offen offset:128 nt
buffer_load_dwordx4 v[156:159], v1, s[48:51], 0 offen offset:256 nt
v_add_u32 v1, s78, v1
s_branch L_pageB
L_agent:
s_mov_b32 s56, s4
s_and_b32 s57, s5, 0xffff
s_mov_b32 s58, 1280
s_mov_b32 s59, 0x20000
s_mov_b32 s40, s24
s_and_b32 s41, s25, 0xffff
s_mov_b32 s42, 1280
s_mov_b32 s43, 0x20000
s_mov_b32 s44, s26
s_and_b32 s45, s27, 0xffff
s_mov_b32 s46, 1280
s_mov_b32 s47, 0x20000
s_mov_b32 s60, s30
s_and_b32 s61, s31, 0xffff
s_mov_b32 s62, 1474560
s_mov_b32 s63, 0x20000
s_mov_b32 s81, 0x3fb8aa3b
v_lshlrev_b32 v8, 2, v0
buffer_load_dword v64, v8, s[56:59], 0 offen offset:0
buffer_load_dword v65, v8, s[56:59], 0 offen offset:256
buffer_load_dword v66, v8, s[56:59], 0 offen offset:512
buffer_load_dword v67, v8, s[56:59], 0 offen offset:768
buffer_load_dword v68, v8, s[56:59], 0 offen offset:1024
buffer_load_dword v69, v8, s[40:43], 0 offen offset:0
buffer_load_dword v70, v8, s[40:43], 0 offen offset:256
buffer_load_dword v71, v8, s[40:43], 0 offen offset:512
buffer_load_dword v72, v8, s[40:43], 0 offen offset:768
buffer_load_dword v73, v8, s[40:43], 0 offen offset:1024
v_mov_b32 v3, 0
v_mov_b32 v38, 0x3f803f80
s_branch L_tB
L_tB_ret:
s_waitcnt vmcnt(0) lgkmcnt(0)
s_add_u32 s32, s32, 0x9e3779b9
v_mov_b32 v1, s32
v_lshlrev_b32 v32, 16, v64
v_and_b32 v33, 0xffff0000, v64
v_lshlrev_b32 v34, 16, v69
v_and_b32 v35, 0xffff0000, v69
v_mul_f32 v32, v32, v34
v_mul_f32 v33, v33, v35
v_cvt_pk_bf16_f32 v36, v32, v33
v_dot2c_f32_bf16 v3, v36, v38
v_lshlrev_b32 v32, 16, v65
v_and_b32 v33, 0xffff0000, v65
v_lshlrev_b32 v34, 16, v70
v_and_b32 v35, 0xffff0000, v70
v_mul_f32 v32, v32, v34
v_mul_f32 v33, v33, v35
v_cvt_pk_bf16_f32 v36, v32, v33
v_dot2c_f32_bf16 v3, v36, v38
v_lshlrev_b32 v32, 16, v66
v_and_b32 v33, 0xffff0000, v66
v_lshlrev_b32 v34, 16, v71
v_and_b32 v35, 0xffff0000, v71
v_mul_f32 v32, v32, v34
v_mul_f32 v33, v33, v35
v_cvt_pk_bf16_f32 v36, v32, v33
v_dot2c_f32_bf16 v3, v36, v38
v_lshlrev_b32 v32, 16, v67
v_and_b32 v33, 0xffff0000, v67
v_lshlrev_b32 v34, 16, v72
v_and_b32 v35, 0xffff0000, v72
v_mul_f32 v32, v32, v34
v_mul_f32 v33, v33, v35
v_cvt_pk_bf16_f32 v36, v32, v33
v_dot2c_f32_bf16 v3, v36, v38
v_lshlrev_b32 v32, 16, v68
v_and_b32 v33, 0xffff0000, v68
v_lshlrev_b32 v34, 16, v73
v_and_b32 v35, 0xffff0000, v73
v_mul_f32 v32, v32, v34
v_mul_f32 v33, v33, v35
v_cvt_pk_bf16_f32 v36, v32, v33
v_dot2c_f32_bf16 v3, v36, v38
s_nop 2
v_add_f32_dpp v3, v3, v3 quad_perm:[1,0,3,2] row_mask:0xf bank_mask:0xf
s_nop 1
v_add_f32_dpp v3, v3, v3 quad_perm:[2,3,0,1] row_mask:0xf bank_mask:0xf
s_nop 1
v_add_f32_dpp v3, v3, v3 row_half_mirror row_mask:0xf bank_mask:0xf
s_nop 1
v_add_f32_dpp v3, v3, v3 row_ror:8 row_mask:0xf bank_mask:0xf
v_mov_b32 v32, v3
s_nop 1
v_permlane16_swap_b32 v3, v32
v_add_f32 v3, v3, v32
v_mov_b32 v32, v3
s_nop 1
v_permlane32_swap_b32 v3, v32
v_add_f32 v3, v3, v32
v_cvt_pk_bf16_f32 v3, 0, v3
v_mul_f32 v32, s81, v3
v_sub_f32 v32, 0, v32
v_exp_f32 v32, v32
s_nop 0
v_add_f32 v32, 1.0, v32
v_rcp_f32 v32, v32
s_nop 0
v_cvt_pk_bf16_f32 v4, 0, v32
v_sub_f32 v5, 1.0, v4
v_cvt_pk_bf16_f32 v5, 0, v5
s_branch L_agent2
.p2align 12
L_tB:
s_branch L_tB_ret
L_pageB:
v_mov_b32 v89, 11392
s_mov_b32 s88, 262144
L_qw:
ds_read_b32 v88, v89
ds_read_b128 v[40:43], v7 offset:0
ds_read_b128 v[44:47], v7 offset:16
ds_read_b128 v[48:51], v7 offset:32
s_waitcnt lgkmcnt(0)
v_readfirstlane_b32 s39, v88
s_cmp_lg_u32 s39, 0
s_cbranch_scc1 L_qw_ok
s_sub_u32 s88, s88, 1
s_cbranch_scc0 L_qw
L_qw_ok:
s_cmp_eq_u32 s36, 0
s_cselect_b32 s79, 9, 9
s_cmp_eq_u32 s33, 4
v_dot2c_f32_bf16 v52, v160, v40
v_dot2c_f32_bf16 v52, v161, v41
v_dot2c_f32_bf16 v52, v162, v42
v_dot2c_f32_bf16 v52, v163, v43
v_dot2c_f32_bf16 v52, v164, v44
v_dot2c_f32_bf16 v52, v165, v45
v_dot2c_f32_bf16 v52, v166, v46
v_dot2c_f32_bf16 v52, v167, v47
v_dot2c_f32_bf16 v52, v168, v48
v_dot2c_f32_bf16 v52, v169, v49
v_dot2c_f32_bf16 v52, v170, v50
v_dot2c_f32_bf16 v52, v171, v51
buffer_load_dwordx4 v[160:163], v1, s[44:47], 0 offen offset:0 nt
buffer_load_dwordx4 v[164:167], v1, s[44:47], 0 offen offset:128 nt
buffer_load_dwordx4 v[168:171], v1, s[44:47], 0 offen offset:256 nt
v_add_f32_dpp v52, v52, v52 quad_perm:[1,0,3,2] row_mask:0xf bank_mask:0xf
s_nop 1
v_add_f32_dpp v52, v52, v52 quad_perm:[2,3,0,1] row_mask:0xf bank_mask:0xf
s_nop 1
v_add_f32_dpp v52, v52, v52 row_half_mirror row_mask:0xf bank_mask:0xf
v_cvt_pk_bf16_f32 v52, 0, v52
v_mul_f32 v52, s80, v52
v_cvt_pk_bf16_f32 v52, 0, v52
v_cmp_gt_f32 vcc, v52, v56
s_cbranch_vccz L_keep1
v_max_f32_dpp v88, v52, v52 row_ror:8 row_mask:0xf bank_mask:0xf
v_mov_b32 v89, v88
s_nop 1
v_permlane16_swap_b32 v88, v89
v_max_f32 v88, v88, v89
v_mov_b32 v89, v88
s_nop 1
v_permlane32_swap_b32 v88, v89
v_max3_f32 v88, v88, v89, v56
v_sub_f32 v89, v56, v88
v_mul_f32 v89, s81, v89
v_exp_f32 v89, v89
v_mov_b32 v56, v88
v_mul_f32 v58, s81, v88
v_mul_f32 v57, v89, v57
v_mul_f32 v16, v89, v16
v_mul_f32 v17, v89, v17
v_mul_f32 v18, v89, v18
v_mul_f32 v19, v89, v19
v_mul_f32 v20, v89, v20
v_mul_f32 v21, v89, v21
v_mul_f32 v22, v89, v22
v_mul_f32 v23, v89, v23
v_mul_f32 v24, v89, v24
v_mul_f32 v25, v89, v25
v_mul_f32 v26, v89, v26
v_mul_f32 v27, v89, v27
v_mul_f32 v28, v89, v28
v_mul_f32 v29, v89, v29
v_mul_f32 v30, v89, v30
v_mul_f32 v31, v89, v31
v_mul_f32 v32, v89, v32
v_mul_f32 v33, v89, v33
v_mul_f32 v34, v89, v34
v_mul_f32 v35, v89, v35
v_mul_f32 v36, v89, v36
v_mul_f32 v37, v89, v37
v_mul_f32 v38, v89, v38
v_mul_f32 v39, v89, v39
L_keep1:
v_fma_f32 v54, v52, s81, -v58
v_exp_f32 v54, v54
v_mov_b32 v52, 0
v_cvt_pk_bf16_f32 v53, v54, 0
v_lshlrev_b32 v54, 16, v53
v_add_f32 v57, v57, v54
v_dot2c_f32_bf16 v16, v172, v53
v_dot2c_f32_bf16 v17, v172, v54
v_dot2c_f32_bf16 v18, v173, v53
v_dot2c_f32_bf16 v19, v173, v54
v_dot2c_f32_bf16 v20, v174, v53
v_dot2c_f32_bf16 v21, v174, v54
v_dot2c_f32_bf16 v22, v175, v53
v_dot2c_f32_bf16 v23, v175, v54
v_dot2c_f32_bf16 v24, v176, v53
v_dot2c_f32_bf16 v25, v176, v54
v_dot2c_f32_bf16 v26, v177, v53
v_dot2c_f32_bf16 v27, v177, v54
v_dot2c_f32_bf16 v28, v178, v53
v_dot2c_f32_bf16 v29, v178, v54
v_dot2c_f32_bf16 v30, v179, v53
v_dot2c_f32_bf16 v31, v179, v54
v_dot2c_f32_bf16 v32, v180, v53
v_dot2c_f32_bf16 v33, v180, v54
v_dot2c_f32_bf16 v34, v181, v53
v_dot2c_f32_bf16 v35, v181, v54
v_dot2c_f32_bf16 v36, v182, v53
v_dot2c_f32_bf16 v37, v182, v54
v_dot2c_f32_bf16 v38, v183, v53
v_dot2c_f32_bf16 v39, v183, v54
buffer_load_dwordx4 v[172:175], v1, s[48:51], 0 offen offset:0 nt
buffer_load_dwordx4 v[176:179], v1, s[48:51], 0 offen offset:128 nt
buffer_load_dwordx4 v[180:183], v1, s[48:51], 0 offen offset:256 nt
v_dot2c_f32_bf16 v52, v184, v40
v_dot2c_f32_bf16 v52, v185, v41
v_dot2c_f32_bf16 v52, v186, v42
v_dot2c_f32_bf16 v52, v187, v43
v_dot2c_f32_bf16 v52, v188, v44
v_dot2c_f32_bf16 v52, v189, v45
v_dot2c_f32_bf16 v52, v190, v46
v_dot2c_f32_bf16 v52, v191, v47
v_dot2c_f32_bf16 v52, v192, v48
v_dot2c_f32_bf16 v52, v193, v49
v_dot2c_f32_bf16 v52, v194, v50
v_dot2c_f32_bf16 v52, v195, v51
s_cbranch_scc0 L_xl1
v_add_u32 v1, s78, v1
buffer_load_dwordx4 v[184:187], v1, s[44:47], 0 offen offset:0 nt
buffer_load_dwordx4 v[188:191], v1, s[44:47], 0 offen offset:128 nt
buffer_load_dwordx4 v[192:195], v1, s[44:47], 0 offen offset:256 nt
L_xl1:
s_nop 1
v_add_f32_dpp v52, v52, v52 quad_perm:[1,0,3,2] row_mask:0xf bank_mask:0xf
s_nop 1
v_add_f32_dpp v52, v52, v52 quad_perm:[2,3,0,1] row_mask:0xf bank_mask:0xf
s_nop 1
v_add_f32_dpp v52, v52, v52 row_half_mirror row_mask:0xf bank_mask:0xf
v_cvt_pk_bf16_f32 v52, 0, v52
v_mul_f32 v52, s80, v52
v_cvt_pk_bf16_f32 v52, 0, v52
v_cmp_gt_f32 vcc, v52, v56
s_cbranch_vccz L_keep2
v_max_f32_dpp v88, v52, v52 row_ror:8 row_mask:0xf bank_mask:0xf
v_mov_b32 v89, v88
s_nop 1
v_permlane16_swap_b32 v88, v89
v_max_f32 v88, v88, v89
v_mov_b32 v89, v88
s_nop 1
v_permlane32_swap_b32 v88, v89
v_max3_f32 v88, v88, v89, v56
v_sub_f32 v89, v56, v88
v_mul_f32 v89, s81, v89
v_exp_f32 v89, v89
v_mov_b32 v56, v88
v_mul_f32 v58, s81, v88
v_mul_f32 v57, v89, v57
v_mul_f32 v16, v89, v16
v_mul_f32 v17, v89, v17
v_mul_f32 v18, v89, v18
v_mul_f32 v19, v89, v19
v_mul_f32 v20, v89, v20
v_mul_f32 v21, v89, v21
v_mul_f32 v22, v89, v22
v_mul_f32 v23, v89, v23
v_mul_f32 v24, v89, v24
v_mul_f32 v25, v89, v25
v_mul_f32 v26, v89, v26
v_mul_f32 v27, v89, v27
v_mul_f32 v28, v89, v28
v_mul_f32 v29, v89, v29
v_mul_f32 v30, v89, v30
v_mul_f32 v31, v89, v31
v_mul_f32 v32, v89, v32
v_mul_f32 v33, v89, v33
v_mul_f32 v34, v89, v34
v_mul_f32 v35, v89, v35
v_mul_f32 v36, v89, v36
v_mul_f32 v37, v89, v37
v_mul_f32 v38, v89, v38
v_mul_f32 v39, v89, v39
L_keep2:
v_fma_f32 v54, v52, s81, -v58
v_exp_f32 v54, v54
v_mov_b32 v52, 0
v_cvt_pk_bf16_f32 v53, v54, 0
v_lshlrev_b32 v54, 16, v53
v_add_f32 v57, v57, v54
v_dot2c_f32_bf16 v16, v196, v53
v_dot2c_f32_bf16 v17, v196, v54
v_dot2c_f32_bf16 v18, v197, v53
v_dot2c_f32_bf16 v19, v197, v54
v_dot2c_f32_bf16 v20, v198, v53
v_dot2c_f32_bf16 v21, v198, v54
v_dot2c_f32_bf16 v22, v199, v53
v_dot2c_f32_bf16 v23, v199, v54
v_dot2c_f32_bf16 v24, v200, v53
v_dot2c_f32_bf16 v25, v200, v54
v_dot2c_f32_bf16 v26, v201, v53
v_dot2c_f32_bf16 v27, v201, v54
v_dot2c_f32_bf16 v28, v202, v53
v_dot2c_f32_bf16 v29, v202, v54
v_dot2c_f32_bf16 v30, v203, v53
v_dot2c_f32_bf16 v31, v203, v54
v_dot2c_f32_bf16 v32, v204, v53
v_dot2c_f32_bf16 v33, v204, v54
v_dot2c_f32_bf16 v34, v205, v53
v_dot2c_f32_bf16 v35, v205, v54
v_dot2c_f32_bf16 v36, v206, v53
v_dot2c_f32_bf16 v37, v206, v54
v_dot2c_f32_bf16 v38, v207, v53
v_dot2c_f32_bf16 v39, v207, v54
s_cbranch_scc0 L_xl2
buffer_load_dwordx4 v[196:199], v1, s[48:51], 0 offen offset:0 nt
buffer_load_dwordx4 v[200:203], v1, s[48:51], 0 offen offset:128 nt
buffer_load_dwordx4 v[204:207], v1, s[48:51], 0 offen offset:256 nt
L_xl2:
v_dot2c_f32_bf16 v52, v208, v40
v_dot2c_f32_bf16 v52, v209, v41
v_dot2c_f32_bf16 v52, v210, v42
v_dot2c_f32_bf16 v52, v211, v43
v_dot2c_f32_bf16 v52, v212, v44
v_dot2c_f32_bf16 v52, v213, v45
v_dot2c_f32_bf16 v52, v214, v46
v_dot2c_f32_bf16 v52, v215, v47
v_dot2c_f32_bf16 v52, v216, v48
v_dot2c_f32_bf16 v52, v217, v49
v_dot2c_f32_bf16 v52, v218, v50
v_dot2c_f32_bf16 v52, v219, v51
s_nop 2
v_add_f32_dpp v52, v52, v52 quad_perm:[1,0,3,2] row_mask:0xf bank_mask:0xf
s_nop 1
v_add_f32_dpp v52, v52, v52 quad_perm:[2,3,0,1] row_mask:0xf bank_mask:0xf
s_nop 1
v_add_f32_dpp v52, v52, v52 row_half_mirror row_mask:0xf bank_mask:0xf
v_cvt_pk_bf16_f32 v52, 0, v52
v_mul_f32 v52, s80, v52
v_cvt_pk_bf16_f32 v52, 0, v52
v_cmp_gt_f32 vcc, v52, v56
s_cbranch_vccz L_keep3
v_max_f32_dpp v88, v52, v52 row_ror:8 row_mask:0xf bank_mask:0xf
v_mov_b32 v89, v88
s_nop 1
v_permlane16_swap_b32 v88, v89
v_max_f32 v88, v88, v89
v_mov_b32 v89, v88
s_nop 1
v_permlane32_swap_b32 v88, v89
v_max3_f32 v88, v88, v89, v56
v_sub_f32 v89, v56, v88
v_mul_f32 v89, s81, v89
v_exp_f32 v89, v89
v_mov_b32 v56, v88
v_mul_f32 v58, s81, v88
v_mul_f32 v57, v89, v57
v_mul_f32 v16, v89, v16
v_mul_f32 v17, v89, v17
v_mul_f32 v18, v89, v18
v_mul_f32 v19, v89, v19
v_mul_f32 v20, v89, v20
v_mul_f32 v21, v89, v21
v_mul_f32 v22, v89, v22
v_mul_f32 v23, v89, v23
v_mul_f32 v24, v89, v24
v_mul_f32 v25, v89, v25
v_mul_f32 v26, v89, v26
v_mul_f32 v27, v89, v27
v_mul_f32 v28, v89, v28
v_mul_f32 v29, v89, v29
v_mul_f32 v30, v89, v30
v_mul_f32 v31, v89, v31
v_mul_f32 v32, v89, v32
v_mul_f32 v33, v89, v33
v_mul_f32 v34, v89, v34
v_mul_f32 v35, v89, v35
v_mul_f32 v36, v89, v36
v_mul_f32 v37, v89, v37
v_mul_f32 v38, v89, v38
v_mul_f32 v39, v89, v39
L_keep3:
v_fma_f32 v54, v52, s81, -v58
v_exp_f32 v54, v54
v_mov_b32 v52, 0
v_cvt_pk_bf16_f32 v53, v54, 0
v_lshlrev_b32 v54, 16, v53
v_add_f32 v57, v57, v54
v_dot2c_f32_bf16 v16, v220, v53
v_dot2c_f32_bf16 v17, v220, v54
v_dot2c_f32_bf16 v18, v221, v53
v_dot2c_f32_bf16 v19, v221, v54
v_dot2c_f32_bf16 v20, v222, v53
v_dot2c_f32_bf16 v21, v222, v54
v_dot2c_f32_bf16 v22, v223, v53
v_dot2c_f32_bf16 v23, v223, v54
v_dot2c_f32_bf16 v24, v224, v53
v_dot2c_f32_bf16 v25, v224, v54
v_dot2c_f32_bf16 v26, v225, v53
v_dot2c_f32_bf16 v27, v225, v54
v_dot2c_f32_bf16 v28, v226, v53
v_dot2c_f32_bf16 v29, v226, v54
v_dot2c_f32_bf16 v30, v227, v53
v_dot2c_f32_bf16 v31, v227, v54
v_dot2c_f32_bf16 v32, v228, v53
v_dot2c_f32_bf16 v33, v228, v54
v_dot2c_f32_bf16 v34, v229, v53
v_dot2c_f32_bf16 v35, v229, v54
v_dot2c_f32_bf16 v36, v230, v53
v_dot2c_f32_bf16 v37, v230, v54
v_dot2c_f32_bf16 v38, v231, v53
v_dot2c_f32_bf16 v39, v231, v54
v_dot2c_f32_bf16 v52, v232, v40
v_dot2c_f32_bf16 v52, v233, v41
v_dot2c_f32_bf16 v52, v234, v42
v_dot2c_f32_bf16 v52, v235, v43
v_dot2c_f32_bf16 v52, v236, v44
v_dot2c_f32_bf16 v52, v237, v45
v_dot2c_f32_bf16 v52, v238, v46
v_dot2c_f32_bf16 v52, v239, v47
v_dot2c_f32_bf16 v52, v240, v48
v_dot2c_f32_bf16 v52, v241, v49
v_dot2c_f32_bf16 v52, v242, v50
v_dot2c_f32_bf16 v52, v243, v51
s_nop 2
v_add_f32_dpp v52, v52, v52 quad_perm:[1,0,3,2] row_mask:0xf bank_mask:0xf
s_nop 1
v_add_f32_dpp v52, v52, v52 quad_perm:[2,3,0,1] row_mask:0xf bank_mask:0xf
s_nop 1
v_add_f32_dpp v52, v52, v52 row_half_mirror row_mask:0xf bank_mask:0xf
v_cvt_pk_bf16_f32 v52, 0, v52
v_mul_f32 v52, s80, v52
v_cvt_pk_bf16_f32 v52, 0, v52
v_cmp_gt_f32 vcc, v52, v56
s_cbranch_vccz L_keep4
v_max_f32_dpp v88, v52, v52 row_ror:8 row_mask:0xf bank_mask:0xf
v_mov_b32 v89, v88
s_nop 1
v_permlane16_swap_b32 v88, v89
v_max_f32 v88, v88, v89
v_mov_b32 v89, v88
s_nop 1
v_permlane32_swap_b32 v88, v89
v_max3_f32 v88, v88, v89, v56
v_sub_f32 v89, v56, v88
v_mul_f32 v89, s81, v89
v_exp_f32 v89, v89
v_mov_b32 v56, v88
v_mul_f32 v58, s81, v88
v_mul_f32 v57, v89, v57
v_mul_f32 v16, v89, v16
v_mul_f32 v17, v89, v17
v_mul_f32 v18, v89, v18
v_mul_f32 v19, v89, v19
v_mul_f32 v20, v89, v20
v_mul_f32 v21, v89, v21
v_mul_f32 v22, v89, v22
v_mul_f32 v23, v89, v23
v_mul_f32 v24, v89, v24
v_mul_f32 v25, v89, v25
v_mul_f32 v26, v89, v26
v_mul_f32 v27, v89, v27
v_mul_f32 v28, v89, v28
v_mul_f32 v29, v89, v29
v_mul_f32 v30, v89, v30
v_mul_f32 v31, v89, v31
v_mul_f32 v32, v89, v32
v_mul_f32 v33, v89, v33
v_mul_f32 v34, v89, v34
v_mul_f32 v35, v89, v35
v_mul_f32 v36, v89, v36
v_mul_f32 v37, v89, v37
v_mul_f32 v38, v89, v38
v_mul_f32 v39, v89, v39
L_keep4:
v_fma_f32 v54, v52, s81, -v58
v_exp_f32 v54, v54
v_mov_b32 v52, 0
v_cvt_pk_bf16_f32 v53, v54, 0
v_lshlrev_b32 v54, 16, v53
v_add_f32 v57, v57, v54
v_dot2c_f32_bf16 v16, v244, v53
v_dot2c_f32_bf16 v17, v244, v54
v_dot2c_f32_bf16 v18, v245, v53
v_dot2c_f32_bf16 v19, v245, v54
v_dot2c_f32_bf16 v20, v246, v53
v_dot2c_f32_bf16 v21, v246, v54
v_dot2c_f32_bf16 v22, v247, v53
v_dot2c_f32_bf16 v23, v247, v54
v_dot2c_f32_bf16 v24, v248, v53
v_dot2c_f32_bf16 v25, v248, v54
v_dot2c_f32_bf16 v26, v249, v53
v_dot2c_f32_bf16 v27, v249, v54
v_dot2c_f32_bf16 v28, v250, v53
v_dot2c_f32_bf16 v29, v250, v54
v_dot2c_f32_bf16 v30, v251, v53
v_dot2c_f32_bf16 v31, v251, v54
v_dot2c_f32_bf16 v32, v252, v53
v_dot2c_f32_bf16 v33, v252, v54
v_dot2c_f32_bf16 v34, v253, v53
v_dot2c_f32_bf16 v35, v253, v54
v_dot2c_f32_bf16 v36, v254, v53
v_dot2c_f32_bf16 v37, v254, v54
v_dot2c_f32_bf16 v38, v255, v53
v_dot2c_f32_bf16 v39, v255, v54
s_waitcnt vmcnt(21)
s_cbranch_scc1 L_xw3
s_waitcnt vmcnt(15)
L_xw3:
v_dot2c_f32_bf16 v52, v112, v40
v_dot2c_f32_bf16 v52, v113, v41
v_dot2c_f32_bf16 v52, v114, v42
v_dot2c_f32_bf16 v52, v115, v43
v_dot2c_f32_bf16 v52, v116, v44
v_dot2c_f32_bf16 v52, v117, v45
v_dot2c_f32_bf16 v52, v118, v46
v_dot2c_f32_bf16 v52, v119, v47
v_dot2c_f32_bf16 v52, v120, v48
v_dot2c_f32_bf16 v52, v121, v49
v_dot2c_f32_bf16 v52, v122, v50
v_dot2c_f32_bf16 v52, v123, v51
s_nop 2
v_add_f32_dpp v52, v52, v52 quad_perm:[1,0,3,2] row_mask:0xf bank_mask:0xf
s_nop 1
v_add_f32_dpp v52, v52, v52 quad_perm:[2,3,0,1] row_mask:0xf bank_mask:0xf
s_nop 1
v_add_f32_dpp v52, v52, v52 row_half_mirror row_mask:0xf bank_mask:0xf
v_cvt_pk_bf16_f32 v52, 0, v52
v_mul_f32 v52, s80, v52
v_cvt_pk_bf16_f32 v52, 0, v52
v_cmp_gt_f32 vcc, v52, v56
s_cbranch_vccz L_keep5
v_max_f32_dpp v88, v52, v52 row_ror:8 row_mask:0xf bank_mask:0xf
v_mov_b32 v89, v88
s_nop 1
v_permlane16_swap_b32 v88, v89
v_max_f32 v88, v88, v89
v_mov_b32 v89, v88
s_nop 1
v_permlane32_swap_b32 v88, v89
v_max3_f32 v88, v88, v89, v56
v_sub_f32 v89, v56, v88
v_mul_f32 v89, s81, v89
v_exp_f32 v89, v89
v_mov_b32 v56, v88
v_mul_f32 v58, s81, v88
v_mul_f32 v57, v89, v57
v_mul_f32 v16, v89, v16
v_mul_f32 v17, v89, v17
v_mul_f32 v18, v89, v18
v_mul_f32 v19, v89, v19
v_mul_f32 v20, v89, v20
v_mul_f32 v21, v89, v21
v_mul_f32 v22, v89, v22
v_mul_f32 v23, v89, v23
v_mul_f32 v24, v89, v24
v_mul_f32 v25, v89, v25
v_mul_f32 v26, v89, v26
v_mul_f32 v27, v89, v27
v_mul_f32 v28, v89, v28
v_mul_f32 v29, v89, v29
v_mul_f32 v30, v89, v30
v_mul_f32 v31, v89, v31
v_mul_f32 v32, v89, v32
v_mul_f32 v33, v89, v33
v_mul_f32 v34, v89, v34
v_mul_f32 v35, v89, v35
v_mul_f32 v36, v89, v36
v_mul_f32 v37, v89, v37
v_mul_f32 v38, v89, v38
v_mul_f32 v39, v89, v39
L_keep5:
v_fma_f32 v54, v52, s81, -v58
v_exp_f32 v54, v54
v_mov_b32 v52, 0
v_cvt_pk_bf16_f32 v53, v54, 0
v_lshlrev_b32 v54, 16, v53
v_add_f32 v57, v57, v54
s_waitcnt vmcnt(18)
s_cbranch_scc1 L_xw4
s_waitcnt vmcnt(12)
L_xw4:
v_dot2c_f32_bf16 v16, v124, v53
v_dot2c_f32_bf16 v17, v124, v54
v_dot2c_f32_bf16 v18, v125, v53
v_dot2c_f32_bf16 v19, v125, v54
v_dot2c_f32_bf16 v20, v126, v53
v_dot2c_f32_bf16 v21, v126, v54
v_dot2c_f32_bf16 v22, v127, v53
v_dot2c_f32_bf16 v23, v127, v54
v_dot2c_f32_bf16 v24, v128, v53
v_dot2c_f32_bf16 v25, v128, v54
v_dot2c_f32_bf16 v26, v129, v53
v_dot2c_f32_bf16 v27, v129, v54
v_dot2c_f32_bf16 v28, v130, v53
v_dot2c_f32_bf16 v29, v130, v54
v_dot2c_f32_bf16 v30, v131, v53
v_dot2c_f32_bf16 v31, v131, v54
v_dot2c_f32_bf16 v32, v132, v53
v_dot2c_f32_bf16 v33, v132, v54
v_dot2c_f32_bf16 v34, v133, v53
v_dot2c_f32_bf16 v35, v133, v54
v_dot2c_f32_bf16 v36, v134, v53
v_dot2c_f32_bf16 v37, v134, v54
v_dot2c_f32_bf16 v38, v135, v53
v_dot2c_f32_bf16 v39, v135, v54
s_waitcnt vmcnt(15)
s_cbranch_scc1 L_xw5
s_waitcnt vmcnt(9)
L_xw5:
v_dot2c_f32_bf16 v52, v136, v40
v_dot2c_f32_bf16 v52, v137, v41
v_dot2c_f32_bf16 v52, v138, v42
v_dot2c_f32_bf16 v52, v139, v43
v_dot2c_f32_bf16 v52, v140, v44
v_dot2c_f32_bf16 v52, v141, v45
v_dot2c_f32_bf16 v52, v142, v46
v_dot2c_f32_bf16 v52, v143, v47
v_dot2c_f32_bf16 v52, v144, v48
v_dot2c_f32_bf16 v52, v145, v49
v_dot2c_f32_bf16 v52, v146, v50
v_dot2c_f32_bf16 v52, v147, v51
s_nop 2
v_add_f32_dpp v52, v52, v52 quad_perm:[1,0,3,2] row_mask:0xf bank_mask:0xf
s_nop 1
v_add_f32_dpp v52, v52, v52 quad_perm:[2,3,0,1] row_mask:0xf bank_mask:0xf
s_nop 1
v_add_f32_dpp v52, v52, v52 row_half_mirror row_mask:0xf bank_mask:0xf
v_cvt_pk_bf16_f32 v52, 0, v52
v_mul_f32 v52, s80, v52
v_cvt_pk_bf16_f32 v52, 0, v52
v_cmp_gt_f32 vcc, v52, v56
s_cbranch_vccz L_keep6
v_max_f32_dpp v88, v52, v52 row_ror:8 row_mask:0xf bank_mask:0xf
v_mov_b32 v89, v88
s_nop 1
v_permlane16_swap_b32 v88, v89
v_max_f32 v88, v88, v89
v_mov_b32 v89, v88
s_nop 1
v_permlane32_swap_b32 v88, v89
v_max3_f32 v88, v88, v89, v56
v_sub_f32 v89, v56, v88
v_mul_f32 v89, s81, v89
v_exp_f32 v89, v89
v_mov_b32 v56, v88
v_mul_f32 v58, s81, v88
v_mul_f32 v57, v89, v57
v_mul_f32 v16, v89, v16
v_mul_f32 v17, v89, v17
v_mul_f32 v18, v89, v18
v_mul_f32 v19, v89, v19
v_mul_f32 v20, v89, v20
v_mul_f32 v21, v89, v21
v_mul_f32 v22, v89, v22
v_mul_f32 v23, v89, v23
v_mul_f32 v24, v89, v24
v_mul_f32 v25, v89, v25
v_mul_f32 v26, v89, v26
v_mul_f32 v27, v89, v27
v_mul_f32 v28, v89, v28
v_mul_f32 v29, v89, v29
v_mul_f32 v30, v89, v30
v_mul_f32 v31, v89, v31
v_mul_f32 v32, v89, v32
v_mul_f32 v33, v89, v33
v_mul_f32 v34, v89, v34
v_mul_f32 v35, v89, v35
v_mul_f32 v36, v89, v36
v_mul_f32 v37, v89, v37
v_mul_f32 v38, v89, v38
v_mul_f32 v39, v89, v39
L_keep6:
v_fma_f32 v54, v52, s81, -v58
v_exp_f32 v54, v54
v_mov_b32 v52, 0
v_cvt_pk_bf16_f32 v53, v54, 0
v_lshlrev_b32 v54, 16, v53
v_add_f32 v57, v57, v54
s_waitcnt vmcnt(12)
s_cbranch_scc1 L_xw6
s_waitcnt vmcnt(6)
L_xw6:
v_dot2c_f32_bf16 v16, v148, v53
v_dot2c_f32_bf16 v17, v148, v54
v_dot2c_f32_bf16 v18, v149, v53
v_dot2c_f32_bf16 v19, v149, v54
v_dot2c_f32_bf16 v20, v150, v53
v_dot2c_f32_bf16 v21, v150, v54
v_dot2c_f32_bf16 v22, v151, v53
v_dot2c_f32_bf16 v23, v151, v54
v_dot2c_f32_bf16 v24, v152, v53
v_dot2c_f32_bf16 v25, v152, v54
v_dot2c_f32_bf16 v26, v153, v53
v_dot2c_f32_bf16 v27, v153, v54
v_dot2c_f32_bf16 v28, v154, v53
v_dot2c_f32_bf16 v29, v154, v54
v_dot2c_f32_bf16 v30, v155, v53
v_dot2c_f32_bf16 v31, v155, v54
v_dot2c_f32_bf16 v32, v156, v53
v_dot2c_f32_bf16 v33, v156, v54
v_dot2c_f32_bf16 v34, v157, v53
v_dot2c_f32_bf16 v35, v157, v54
v_dot2c_f32_bf16 v36, v158, v53
v_dot2c_f32_bf16 v37, v158, v54
v_dot2c_f32_bf16 v38, v159, v53
v_dot2c_f32_bf16 v39, v159, v54
s_cbranch_scc0 L_loop0
s_sub_u32 s79, s79, 2
s_waitcnt vmcnt(9)
v_dot2c_f32_bf16 v52, v160, v40
v_dot2c_f32_bf16 v52, v161, v41
v_dot2c_f32_bf16 v52, v162, v42
v_dot2c_f32_bf16 v52, v163, v43
v_dot2c_f32_bf16 v52, v164, v44
v_dot2c_f32_bf16 v52, v165, v45
v_dot2c_f32_bf16 v52, v166, v46
v_dot2c_f32_bf16 v52, v167, v47
v_dot2c_f32_bf16 v52, v168, v48
v_dot2c_f32_bf16 v52, v169, v49
v_dot2c_f32_bf16 v52, v170, v50
v_dot2c_f32_bf16 v52, v171, v51
s_nop 2
v_add_f32_dpp v52, v52, v52 quad_perm:[1,0,3,2] row_mask:0xf bank_mask:0xf
s_nop 1
v_add_f32_dpp v52, v52, v52 quad_perm:[2,3,0,1] row_mask:0xf bank_mask:0xf
s_nop 1
v_add_f32_dpp v52, v52, v52 row_half_mirror row_mask:0xf bank_mask:0xf
v_cvt_pk_bf16_f32 v52, 0, v52
v_mul_f32 v52, s80, v52
v_cvt_pk_bf16_f32 v52, 0, v52
v_cmp_gt_f32 vcc, v52, v56
s_cbranch_vccz L_keep7
v_max_f32_dpp v88, v52, v52 row_ror:8 row_mask:0xf bank_mask:0xf
v_mov_b32 v89, v88
s_nop 1
v_permlane16_swap_b32 v88, v89
v_max_f32 v88, v88, v89
v_mov_b32 v89, v88
s_nop 1
v_permlane32_swap_b32 v88, v89
v_max3_f32 v88, v88, v89, v56
v_sub_f32 v89, v56, v88
v_mul_f32 v89, s81, v89
v_exp_f32 v89, v89
v_mov_b32 v56, v88
v_mul_f32 v58, s81, v88
v_mul_f32 v57, v89, v57
v_mul_f32 v16, v89, v16
v_mul_f32 v17, v89, v17
v_mul_f32 v18, v89, v18
v_mul_f32 v19, v89, v19
v_mul_f32 v20, v89, v20
v_mul_f32 v21, v89, v21
v_mul_f32 v22, v89, v22
v_mul_f32 v23, v89, v23
v_mul_f32 v24, v89, v24
v_mul_f32 v25, v89, v25
v_mul_f32 v26, v89, v26
v_mul_f32 v27, v89, v27
v_mul_f32 v28, v89, v28
v_mul_f32 v29, v89, v29
v_mul_f32 v30, v89, v30
v_mul_f32 v31, v89, v31
v_mul_f32 v32, v89, v32
v_mul_f32 v33, v89, v33
v_mul_f32 v34, v89, v34
v_mul_f32 v35, v89, v35
v_mul_f32 v36, v89, v36
v_mul_f32 v37, v89, v37
v_mul_f32 v38, v89, v38
v_mul_f32 v39, v89, v39
L_keep7:
v_fma_f32 v54, v52, s81, -v58
v_exp_f32 v54, v54
v_mov_b32 v52, 0
v_cvt_pk_bf16_f32 v53, v54, 0
v_lshlrev_b32 v54, 16, v53
v_add_f32 v57, v57, v54
s_waitcnt vmcnt(6)
v_dot2c_f32_bf16 v16, v172, v53
v_dot2c_f32_bf16 v17, v172, v54
v_dot2c_f32_bf16 v18, v173, v53
v_dot2c_f32_bf16 v19, v173, v54
v_dot2c_f32_bf16 v20, v174, v53
v_dot2c_f32_bf16 v21, v174, v54
v_dot2c_f32_bf16 v22, v175, v53
v_dot2c_f32_bf16 v23, v175, v54
v_dot2c_f32_bf16 v24, v176, v53
v_dot2c_f32_bf16 v25, v176, v54
v_dot2c_f32_bf16 v26, v177, v53
v_dot2c_f32_bf16 v27, v177, v54
v_dot2c_f32_bf16 v28, v178, v53
v_dot2c_f32_bf16 v29, v178, v54
v_dot2c_f32_bf16 v30, v179, v53
v_dot2c_f32_bf16 v31, v179, v54
v_dot2c_f32_bf16 v32, v180, v53
v_dot2c_f32_bf16 v33, v180, v54
v_dot2c_f32_bf16 v34, v181, v53
v_dot2c_f32_bf16 v35, v181, v54
v_dot2c_f32_bf16 v36, v182, v53
v_dot2c_f32_bf16 v37, v182, v54
v_dot2c_f32_bf16 v38, v183, v53
v_dot2c_f32_bf16 v39, v183, v54
s_waitcnt vmcnt(3)
v_add_u32 v1, s78, v1
buffer_load_dwordx4 v[136:139], v1, s[44:47], 0 offen offset:0 nt
buffer_load_dwordx4 v[140:143], v1, s[44:47], 0 offen offset:128 nt
buffer_load_dwordx4 v[144:147], v1, s[44:47], 0 offen offset:256 nt
v_dot2c_f32_bf16 v52, v184, v40
v_dot2c_f32_bf16 v52, v185, v41
v_dot2c_f32_bf16 v52, v186, v42
v_dot2c_f32_bf16 v52, v187, v43
v_dot2c_f32_bf16 v52, v188, v44
v_dot2c_f32_bf16 v52, v189, v45
v_dot2c_f32_bf16 v52, v190, v46
v_dot2c_f32_bf16 v52, v191, v47
v_dot2c_f32_bf16 v52, v192, v48
v_dot2c_f32_bf16 v52, v193, v49
v_dot2c_f32_bf16 v52, v194, v50
v_dot2c_f32_bf16 v52, v195, v51
s_nop 2
v_add_f32_dpp v52, v52, v52 quad_perm:[1,0,3,2] row_mask:0xf bank_mask:0xf
s_nop 1
v_add_f32_dpp v52, v52, v52 quad_perm:[2,3,0,1] row_mask:0xf bank_mask:0xf
s_nop 1
v_add_f32_dpp v52, v52, v52 row_half_mirror row_mask:0xf bank_mask:0xf
v_cvt_pk_bf16_f32 v52, 0, v52
v_mul_f32 v52, s80, v52
v_cvt_pk_bf16_f32 v52, 0, v52
v_cmp_gt_f32 vcc, v52, v56
s_cbranch_vccz L_keep8
v_max_f32_dpp v88, v52, v52 row_ror:8 row_mask:0xf bank_mask:0xf
v_mov_b32 v89, v88
s_nop 1
v_permlane16_swap_b32 v88, v89
v_max_f32 v88, v88, v89
v_mov_b32 v89, v88
s_nop 1
v_permlane32_swap_b32 v88, v89
v_max3_f32 v88, v88, v89, v56
v_sub_f32 v89, v56, v88
v_mul_f32 v89, s81, v89
v_exp_f32 v89, v89
v_mov_b32 v56, v88
v_mul_f32 v58, s81, v88
v_mul_f32 v57, v89, v57
v_mul_f32 v16, v89, v16
v_mul_f32 v17, v89, v17
v_mul_f32 v18, v89, v18
v_mul_f32 v19, v89, v19
v_mul_f32 v20, v89, v20
v_mul_f32 v21, v89, v21
v_mul_f32 v22, v89, v22
v_mul_f32 v23, v89, v23
v_mul_f32 v24, v89, v24
v_mul_f32 v25, v89, v25
v_mul_f32 v26, v89, v26
v_mul_f32 v27, v89, v27
v_mul_f32 v28, v89, v28
v_mul_f32 v29, v89, v29
v_mul_f32 v30, v89, v30
v_mul_f32 v31, v89, v31
v_mul_f32 v32, v89, v32
v_mul_f32 v33, v89, v33
v_mul_f32 v34, v89, v34
v_mul_f32 v35, v89, v35
v_mul_f32 v36, v89, v36
v_mul_f32 v37, v89, v37
v_mul_f32 v38, v89, v38
v_mul_f32 v39, v89, v39
L_keep8:
v_fma_f32 v54, v52, s81, -v58
v_exp_f32 v54, v54
v_mov_b32 v52, 0
v_cvt_pk_bf16_f32 v53, v54, 0
v_lshlrev_b32 v54, 16, v53
v_add_f32 v57, v57, v54
s_waitcnt vmcnt(3)
buffer_load_dwordx4 v[148:151], v1, s[48:51], 0 offen offset:0 nt
buffer_load_dwordx4 v[152:155], v1, s[48:51], 0 offen offset:128 nt
buffer_load_dwordx4 v[156:159], v1, s[48:51], 0 offen offset:256 nt
v_dot2c_f32_bf16 v16, v196, v53
v_dot2c_f32_bf16 v17, v196, v54
v_dot2c_f32_bf16 v18, v197, v53
v_dot2c_f32_bf16 v19, v197, v54
v_dot2c_f32_bf16 v20, v198, v53
v_dot2c_f32_bf16 v21, v198, v54
v_dot2c_f32_bf16 v22, v199, v53
v_dot2c_f32_bf16 v23, v199, v54
v_dot2c_f32_bf16 v24, v200, v53
v_dot2c_f32_bf16 v25, v200, v54
v_dot2c_f32_bf16 v26, v201, v53
v_dot2c_f32_bf16 v27, v201, v54
v_dot2c_f32_bf16 v28, v202, v53
v_dot2c_f32_bf16 v29, v202, v54
v_dot2c_f32_bf16 v30, v203, v53
v_dot2c_f32_bf16 v31, v203, v54
v_dot2c_f32_bf16 v32, v204, v53
v_dot2c_f32_bf16 v33, v204, v54
v_dot2c_f32_bf16 v34, v205, v53
v_dot2c_f32_bf16 v35, v205, v54
v_dot2c_f32_bf16 v36, v206, v53
v_dot2c_f32_bf16 v37, v206, v54
v_dot2c_f32_bf16 v38, v207, v53
v_dot2c_f32_bf16 v39, v207, v54
s_branch L_loop1
L_loop0:
s_sub_u32 s79, s79, 1
s_waitcnt vmcnt(3)
s_cbranch_scc1 L_last0
v_add_u32 v1, s78, v1
buffer_load_dwordx4 v[136:139], v1, s[44:47], 0 offen offset:0 nt
buffer_load_dwordx4 v[140:143], v1, s[44:47], 0 offen offset:128 nt
buffer_load_dwordx4 v[144:147], v1, s[44:47], 0 offen offset:256 nt
v_dot2c_f32_bf16 v52, v160, v40
v_dot2c_f32_bf16 v52, v161, v41
v_dot2c_f32_bf16 v52, v162, v42
v_dot2c_f32_bf16 v52, v163, v43
v_dot2c_f32_bf16 v52, v164, v44
v_dot2c_f32_bf16 v52, v165, v45
v_dot2c_f32_bf16 v52, v166, v46
v_dot2c_f32_bf16 v52, v167, v47
v_dot2c_f32_bf16 v52, v168, v48
v_dot2c_f32_bf16 v52, v169, v49
v_dot2c_f32_bf16 v52, v170, v50
v_dot2c_f32_bf16 v52, v171, v51
s_nop 2
v_add_f32_dpp v52, v52, v52 quad_perm:[1,0,3,2] row_mask:0xf bank_mask:0xf
s_nop 1
v_add_f32_dpp v52, v52, v52 quad_perm:[2,3,0,1] row_mask:0xf bank_mask:0xf
s_nop 1
v_add_f32_dpp v52, v52, v52 row_half_mirror row_mask:0xf bank_mask:0xf
v_cvt_pk_bf16_f32 v52, 0, v52
v_mul_f32 v52, s80, v52
v_cvt_pk_bf16_f32 v52, 0, v52
v_cmp_gt_f32 vcc, v52, v56
s_cbranch_vccz L_keep9
v_max_f32_dpp v88, v52, v52 row_ror:8 row_mask:0xf bank_mask:0xf
v_mov_b32 v89, v88
s_nop 1
v_permlane16_swap_b32 v88, v89
v_max_f32 v88, v88, v89
v_mov_b32 v89, v88
s_nop 1
v_permlane32_swap_b32 v88, v89
v_max3_f32 v88, v88, v89, v56
v_sub_f32 v89, v56, v88
v_mul_f32 v89, s81, v89
v_exp_f32 v89, v89
v_mov_b32 v56, v88
v_mul_f32 v58, s81, v88
v_mul_f32 v57, v89, v57
v_mul_f32 v16, v89, v16
v_mul_f32 v17, v89, v17
v_mul_f32 v18, v89, v18
v_mul_f32 v19, v89, v19
v_mul_f32 v20, v89, v20
v_mul_f32 v21, v89, v21
v_mul_f32 v22, v89, v22
v_mul_f32 v23, v89, v23
v_mul_f32 v24, v89, v24
v_mul_f32 v25, v89, v25
v_mul_f32 v26, v89, v26
v_mul_f32 v27, v89, v27
v_mul_f32 v28, v89, v28
v_mul_f32 v29, v89, v29
v_mul_f32 v30, v89, v30
v_mul_f32 v31, v89, v31
v_mul_f32 v32, v89, v32
v_mul_f32 v33, v89, v33
v_mul_f32 v34, v89, v34
v_mul_f32 v35, v89, v35
v_mul_f32 v36, v89, v36
v_mul_f32 v37, v89, v37
v_mul_f32 v38, v89, v38
v_mul_f32 v39, v89, v39
L_keep9:
v_fma_f32 v54, v52, s81, -v58
v_exp_f32 v54, v54
v_mov_b32 v52, 0
v_cvt_pk_bf16_f32 v53, v54, 0
v_lshlrev_b32 v54, 16, v53
v_add_f32 v57, v57, v54
s_waitcnt vmcnt(3)
buffer_load_dwordx4 v[148:151], v1, s[48:51], 0 offen offset:0 nt
buffer_load_dwordx4 v[152:155], v1, s[48:51], 0 offen offset:128 nt
buffer_load_dwordx4 v[156:159], v1, s[48:51], 0 offen offset:256 nt
v_dot2c_f32_bf16 v16, v172, v53
v_dot2c_f32_bf16 v17, v172, v54
v_dot2c_f32_bf16 v18, v173, v53
v_dot2c_f32_bf16 v19, v173, v54
v_dot2c_f32_bf16 v20, v174, v53
v_dot2c_f32_bf16 v21, v174, v54
v_dot2c_f32_bf16 v22, v175, v53
v_dot2c_f32_bf16 v23, v175, v54
v_dot2c_f32_bf16 v24, v176, v53
v_dot2c_f32_bf16 v25, v176, v54
v_dot2c_f32_bf16 v26, v177, v53
v_dot2c_f32_bf16 v27, v177, v54
v_dot2c_f32_bf16 v28, v178, v53
v_dot2c_f32_bf16 v29, v178, v54
v_dot2c_f32_bf16 v30, v179, v53
v_dot2c_f32_bf16 v31, v179, v54
v_dot2c_f32_bf16 v32, v180, v53
v_dot2c_f32_bf16 v33, v180, v54
v_dot2c_f32_bf16 v34, v181, v53
v_dot2c_f32_bf16 v35, v181, v54
v_dot2c_f32_bf16 v36, v182, v53
v_dot2c_f32_bf16 v37, v182, v54
v_dot2c_f32_bf16 v38, v183, v53
v_dot2c_f32_bf16 v39, v183, v54
L_loop1:
s_sub_u32 s79, s79, 1
s_waitcnt vmcnt(3)
s_cbranch_scc1 L_last1
v_add_u32 v1, s78, v1
buffer_load_dwordx4 v[160:163], v1, s[44:47], 0 offen offset:0 nt
buffer_load_dwordx4 v[164:167], v1, s[44:47], 0 offen offset:128 nt
buffer_load_dwordx4 v[168:171], v1, s[44:47], 0 offen offset:256 nt
v_dot2c_f32_bf16 v52, v136, v40
v_dot2c_f32_bf16 v52, v137, v41
v_dot2c_f32_bf16 v52, v138, v42
v_dot2c_f32_bf16 v52, v139, v43
v_dot2c_f32_bf16 v52, v140, v44
v_dot2c_f32_bf16 v52, v141, v45
v_dot2c_f32_bf16 v52, v142, v46
v_dot2c_f32_bf16 v52, v143, v47
v_dot2c_f32_bf16 v52, v144, v48
v_dot2c_f32_bf16 v52, v145, v49
v_dot2c_f32_bf16 v52, v146, v50
v_dot2c_f32_bf16 v52, v147, v51
s_nop 2
v_add_f32_dpp v52, v52, v52 quad_perm:[1,0,3,2] row_mask:0xf bank_mask:0xf
s_nop 1
v_add_f32_dpp v52, v52, v52 quad_perm:[2,3,0,1] row_mask:0xf bank_mask:0xf
s_nop 1
v_add_f32_dpp v52, v52, v52 row_half_mirror row_mask:0xf bank_mask:0xf
v_cvt_pk_bf16_f32 v52, 0, v52
v_mul_f32 v52, s80, v52
v_cvt_pk_bf16_f32 v52, 0, v52
v_cmp_gt_f32 vcc, v52, v56
s_cbranch_vccz L_keep10
v_max_f32_dpp v88, v52, v52 row_ror:8 row_mask:0xf bank_mask:0xf
v_mov_b32 v89, v88
s_nop 1
v_permlane16_swap_b32 v88, v89
v_max_f32 v88, v88, v89
v_mov_b32 v89, v88
s_nop 1
v_permlane32_swap_b32 v88, v89
v_max3_f32 v88, v88, v89, v56
v_sub_f32 v89, v56, v88
v_mul_f32 v89, s81, v89
v_exp_f32 v89, v89
v_mov_b32 v56, v88
v_mul_f32 v58, s81, v88
v_mul_f32 v57, v89, v57
v_mul_f32 v16, v89, v16
v_mul_f32 v17, v89, v17
v_mul_f32 v18, v89, v18
v_mul_f32 v19, v89, v19
v_mul_f32 v20, v89, v20
v_mul_f32 v21, v89, v21
v_mul_f32 v22, v89, v22
v_mul_f32 v23, v89, v23
v_mul_f32 v24, v89, v24
v_mul_f32 v25, v89, v25
v_mul_f32 v26, v89, v26
v_mul_f32 v27, v89, v27
v_mul_f32 v28, v89, v28
v_mul_f32 v29, v89, v29
v_mul_f32 v30, v89, v30
v_mul_f32 v31, v89, v31
v_mul_f32 v32, v89, v32
v_mul_f32 v33, v89, v33
v_mul_f32 v34, v89, v34
v_mul_f32 v35, v89, v35
v_mul_f32 v36, v89, v36
v_mul_f32 v37, v89, v37
v_mul_f32 v38, v89, v38
v_mul_f32 v39, v89, v39
L_keep10:
v_fma_f32 v54, v52, s81, -v58
v_exp_f32 v54, v54
v_mov_b32 v52, 0
v_cvt_pk_bf16_f32 v53, v54, 0
v_lshlrev_b32 v54, 16, v53
v_add_f32 v57, v57, v54
s_waitcnt vmcnt(3)
buffer_load_dwordx4 v[172:175], v1, s[48:51], 0 offen offset:0 nt
buffer_load_dwordx4 v[176:179], v1, s[48:51], 0 offen offset:128 nt
buffer_load_dwordx4 v[180:183], v1, s[48:51], 0 offen offset:256 nt
v_dot2c_f32_bf16 v16, v148, v53
v_dot2c_f32_bf16 v17, v148, v54
v_dot2c_f32_bf16 v18, v149, v53
v_dot2c_f32_bf16 v19, v149, v54
v_dot2c_f32_bf16 v20, v150, v53
v_dot2c_f32_bf16 v21, v150, v54
v_dot2c_f32_bf16 v22, v151, v53
v_dot2c_f32_bf16 v23, v151, v54
v_dot2c_f32_bf16 v24, v152, v53
v_dot2c_f32_bf16 v25, v152, v54
v_dot2c_f32_bf16 v26, v153, v53
v_dot2c_f32_bf16 v27, v153, v54
v_dot2c_f32_bf16 v28, v154, v53
v_dot2c_f32_bf16 v29, v154, v54
v_dot2c_f32_bf16 v30, v155, v53
v_dot2c_f32_bf16 v31, v155, v54
v_dot2c_f32_bf16 v32, v156, v53
v_dot2c_f32_bf16 v33, v156, v54
v_dot2c_f32_bf16 v34, v157, v53
v_dot2c_f32_bf16 v35, v157, v54
v_dot2c_f32_bf16 v36, v158, v53
v_dot2c_f32_bf16 v37, v158, v54
v_dot2c_f32_bf16 v38, v159, v53
v_dot2c_f32_bf16 v39, v159, v54
s_branch L_loop0
.p2align 12
L_tC0:
s_branch L_tC1
L_last0:
v_add_u32 v88, s64, v4
v_add_u32 v89, s65, v4
v_add_u32 v90, s66, v4
buffer_load_dwordx4 v[184:187], v88, s[52:55], 0 offen nt
buffer_load_dwordx4 v[188:191], v89, s[52:55], 0 offen nt
buffer_load_dwordx4 v[192:195], v90, s[52:55], 0 offen nt
v_add_u32 v88, s67, v4
v_add_u32 v89, s68, v4
v_add_u32 v90, s69, v4
buffer_load_dwordx4 v[196:199], v88, s[52:55], 0 offen nt
buffer_load_dwordx4 v[200:203], v89, s[52:55], 0 offen nt
buffer_load_dwordx4 v[204:207], v90, s[52:55], 0 offen nt
v_dot2c_f32_bf16 v52, v160, v40
v_dot2c_f32_bf16 v52, v161, v41
v_dot2c_f32_bf16 v52, v162, v42
v_dot2c_f32_bf16 v52, v163, v43
v_dot2c_f32_bf16 v52, v164, v44
v_dot2c_f32_bf16 v52, v165, v45
v_dot2c_f32_bf16 v52, v166, v46
v_dot2c_f32_bf16 v52, v167, v47
v_dot2c_f32_bf16 v52, v168, v48
v_dot2c_f32_bf16 v52, v169, v49
v_dot2c_f32_bf16 v52, v170, v50
v_dot2c_f32_bf16 v52, v171, v51
s_nop 2
v_add_f32_dpp v52, v52, v52 quad_perm:[1,0,3,2] row_mask:0xf bank_mask:0xf
s_nop 1
v_add_f32_dpp v52, v52, v52 quad_perm:[2,3,0,1] row_mask:0xf bank_mask:0xf
s_nop 1
v_add_f32_dpp v52, v52, v52 row_half_mirror row_mask:0xf bank_mask:0xf
v_cvt_pk_bf16_f32 v52, 0, v52
v_mul_f32 v52, s80, v52
v_cvt_pk_bf16_f32 v52, 0, v52
v_cmp_gt_f32 vcc, v52, v56
s_cbranch_vccz L_keep11
v_max_f32_dpp v88, v52, v52 row_ror:8 row_mask:0xf bank_mask:0xf
v_mov_b32 v89, v88
s_nop 1
v_permlane16_swap_b32 v88, v89
v_max_f32 v88, v88, v89
v_mov_b32 v89, v88
s_nop 1
v_permlane32_swap_b32 v88, v89
v_max3_f32 v88, v88, v89, v56
v_sub_f32 v89, v56, v88
v_mul_f32 v89, s81, v89
v_exp_f32 v89, v89
v_mov_b32 v56, v88
v_mul_f32 v58, s81, v88
v_mul_f32 v57, v89, v57
v_mul_f32 v16, v89, v16
v_mul_f32 v17, v89, v17
v_mul_f32 v18, v89, v18
v_mul_f32 v19, v89, v19
v_mul_f32 v20, v89, v20
v_mul_f32 v21, v89, v21
v_mul_f32 v22, v89, v22
v_mul_f32 v23, v89, v23
v_mul_f32 v24, v89, v24
v_mul_f32 v25, v89, v25
v_mul_f32 v26, v89, v26
v_mul_f32 v27, v89, v27
v_mul_f32 v28, v89, v28
v_mul_f32 v29, v89, v29
v_mul_f32 v30, v89, v30
v_mul_f32 v31, v89, v31
v_mul_f32 v32, v89, v32
v_mul_f32 v33, v89, v33
v_mul_f32 v34, v89, v34
v_mul_f32 v35, v89, v35
v_mul_f32 v36, v89, v36
v_mul_f32 v37, v89, v37
v_mul_f32 v38, v89, v38
v_mul_f32 v39, v89, v39
L_keep11:
v_fma_f32 v54, v52, s81, -v58
v_exp_f32 v54, v54
v_mov_b32 v52, 0
v_cvt_pk_bf16_f32 v53, v54, 0
v_lshlrev_b32 v54, 16, v53
v_add_f32 v57, v57, v54
s_nop 1
v_add_f32_dpp v57, v57, v57 row_ror:8 row_mask:0xf bank_mask:0xf
v_mov_b32 v88, v57
s_nop 1
v_permlane16_swap_b32 v57, v88
v_add_f32 v57, v57, v88
v_mov_b32 v88, v57
s_nop 1
v_permlane32_swap_b32 v57, v88
v_add_f32 v57, v57, v88
s_mov_b64 exec, 1
ds_write_b64 v9, v[56:57]
s_mov_b64 exec, -1
s_waitcnt lgkmcnt(0)
v_mov_b32 v95, 2
s_mov_b64 exec, 1
ds_write_b32 v10, v95
s_mov_b64 exec, -1
s_waitcnt vmcnt(6)
v_add_u32 v88, s70, v4
v_add_u32 v89, s71, v4
v_add_u32 v90, s72, v4
buffer_load_dwordx4 v[208:211], v88, s[52:55], 0 offen nt
buffer_load_dwordx4 v[212:215], v89, s[52:55], 0 offen nt
buffer_load_dwordx4 v[216:219], v90, s[52:55], 0 offen nt
v_add_u32 v88, s73, v4
v_add_u32 v89, s74, v4
v_add_u32 v90, s75, v4
buffer_load_dwordx4 v[220:223], v88, s[52:55], 0 offen nt
buffer_load_dwordx4 v[224:227], v89, s[52:55], 0 offen nt
buffer_load_dwordx4 v[228:231], v90, s[52:55], 0 offen nt
v_dot2c_f32_bf16 v16, v172, v53
v_dot2c_f32_bf16 v17, v172, v54
v_dot2c_f32_bf16 v18, v173, v53
v_dot2c_f32_bf16 v19, v173, v54
v_dot2c_f32_bf16 v20, v174, v53
v_dot2c_f32_bf16 v21, v174, v54
v_dot2c_f32_bf16 v22, v175, v53
v_dot2c_f32_bf16 v23, v175, v54
v_dot2c_f32_bf16 v24, v176, v53
v_dot2c_f32_bf16 v25, v176, v54
v_dot2c_f32_bf16 v26, v177, v53
v_dot2c_f32_bf16 v27, v177, v54
v_dot2c_f32_bf16 v28, v178, v53
v_dot2c_f32_bf16 v29, v178, v54
v_dot2c_f32_bf16 v30, v179, v53
v_dot2c_f32_bf16 v31, v179, v54
v_dot2c_f32_bf16 v32, v180, v53
v_dot2c_f32_bf16 v33, v180, v54
v_dot2c_f32_bf16 v34, v181, v53
v_dot2c_f32_bf16 v35, v181, v54
v_dot2c_f32_bf16 v36, v182, v53
v_dot2c_f32_bf16 v37, v182, v54
v_dot2c_f32_bf16 v38, v183, v53
v_dot2c_f32_bf16 v39, v183, v54
s_branch L_tail
L_tC1:
s_branch L_tC2
L_last1:
v_add_u32 v88, s64, v4
v_add_u32 v89, s65, v4
v_add_u32 v90, s66, v4
buffer_load_dwordx4 v[184:187], v88, s[52:55], 0 offen nt
buffer_load_dwordx4 v[188:191], v89, s[52:55], 0 offen nt
buffer_load_dwordx4 v[192:195], v90, s[52:55], 0 offen nt
v_add_u32 v88, s67, v4
v_add_u32 v89, s68, v4
v_add_u32 v90, s69, v4
buffer_load_dwordx4 v[196:199], v88, s[52:55], 0 offen nt
buffer_load_dwordx4 v[200:203], v89, s[52:55], 0 offen nt
buffer_load_dwordx4 v[204:207], v90, s[52:55], 0 offen nt
v_dot2c_f32_bf16 v52, v136, v40
v_dot2c_f32_bf16 v52, v137, v41
v_dot2c_f32_bf16 v52, v138, v42
v_dot2c_f32_bf16 v52, v139, v43
v_dot2c_f32_bf16 v52, v140, v44
v_dot2c_f32_bf16 v52, v141, v45
v_dot2c_f32_bf16 v52, v142, v46
v_dot2c_f32_bf16 v52, v143, v47
v_dot2c_f32_bf16 v52, v144, v48
v_dot2c_f32_bf16 v52, v145, v49
v_dot2c_f32_bf16 v52, v146, v50
v_dot2c_f32_bf16 v52, v147, v51
s_nop 2
v_add_f32_dpp v52, v52, v52 quad_perm:[1,0,3,2] row_mask:0xf bank_mask:0xf
s_nop 1
v_add_f32_dpp v52, v52, v52 quad_perm:[2,3,0,1] row_mask:0xf bank_mask:0xf
s_nop 1
v_add_f32_dpp v52, v52, v52 row_half_mirror row_mask:0xf bank_mask:0xf
v_cvt_pk_bf16_f32 v52, 0, v52
v_mul_f32 v52, s80, v52
v_cvt_pk_bf16_f32 v52, 0, v52
v_cmp_gt_f32 vcc, v52, v56
s_cbranch_vccz L_keep12
v_max_f32_dpp v88, v52, v52 row_ror:8 row_mask:0xf bank_mask:0xf
v_mov_b32 v89, v88
s_nop 1
v_permlane16_swap_b32 v88, v89
v_max_f32 v88, v88, v89
v_mov_b32 v89, v88
s_nop 1
v_permlane32_swap_b32 v88, v89
v_max3_f32 v88, v88, v89, v56
v_sub_f32 v89, v56, v88
v_mul_f32 v89, s81, v89
v_exp_f32 v89, v89
v_mov_b32 v56, v88
v_mul_f32 v58, s81, v88
v_mul_f32 v57, v89, v57
v_mul_f32 v16, v89, v16
v_mul_f32 v17, v89, v17
v_mul_f32 v18, v89, v18
v_mul_f32 v19, v89, v19
v_mul_f32 v20, v89, v20
v_mul_f32 v21, v89, v21
v_mul_f32 v22, v89, v22
v_mul_f32 v23, v89, v23
v_mul_f32 v24, v89, v24
v_mul_f32 v25, v89, v25
v_mul_f32 v26, v89, v26
v_mul_f32 v27, v89, v27
v_mul_f32 v28, v89, v28
v_mul_f32 v29, v89, v29
v_mul_f32 v30, v89, v30
v_mul_f32 v31, v89, v31
v_mul_f32 v32, v89, v32
v_mul_f32 v33, v89, v33
v_mul_f32 v34, v89, v34
v_mul_f32 v35, v89, v35
v_mul_f32 v36, v89, v36
v_mul_f32 v37, v89, v37
v_mul_f32 v38, v89, v38
v_mul_f32 v39, v89, v39
L_keep12:
v_fma_f32 v54, v52, s81, -v58
v_exp_f32 v54, v54
v_mov_b32 v52, 0
v_cvt_pk_bf16_f32 v53, v54, 0
v_lshlrev_b32 v54, 16, v53
v_add_f32 v57, v57, v54
s_nop 1
v_add_f32_dpp v57, v57, v57 row_ror:8 row_mask:0xf bank_mask:0xf
v_mov_b32 v88, v57
s_nop 1
v_permlane16_swap_b32 v57, v88
v_add_f32 v57, v57, v88
v_mov_b32 v88, v57
s_nop 1
v_permlane32_swap_b32 v57, v88
v_add_f32 v57, v57, v88
s_mov_b64 exec, 1
ds_write_b64 v9, v[56:57]
s_mov_b64 exec, -1
s_waitcnt lgkmcnt(0)
v_mov_b32 v95, 2
s_mov_b64 exec, 1
ds_write_b32 v10, v95
s_mov_b64 exec, -1
s_waitcnt vmcnt(6)
v_add_u32 v88, s70, v4
v_add_u32 v89, s71, v4
v_add_u32 v90, s72, v4
buffer_load_dwordx4 v[208:211], v88, s[52:55], 0 offen nt
buffer_load_dwordx4 v[212:215], v89, s[52:55], 0 offen nt
buffer_load_dwordx4 v[216:219], v90, s[52:55], 0 offen nt
v_add_u32 v88, s73, v4
v_add_u32 v89, s74, v4
v_add_u32 v90, s75, v4
buffer_load_dwordx4 v[220:223], v88, s[52:55], 0 offen nt
buffer_load_dwordx4 v[224:227], v89, s[52:55], 0 offen nt
buffer_load_dwordx4 v[228:231], v90, s[52:55], 0 offen nt
v_dot2c_f32_bf16 v16, v148, v53
v_dot2c_f32_bf16 v17, v148, v54
v_dot2c_f32_bf16 v18, v149, v53
v_dot2c_f32_bf16 v19, v149, v54
v_dot2c_f32_bf16 v20, v150, v53
v_dot2c_f32_bf16 v21, v150, v54
v_dot2c_f32_bf16 v22, v151, v53
v_dot2c_f32_bf16 v23, v151, v54
v_dot2c_f32_bf16 v24, v152, v53
v_dot2c_f32_bf16 v25, v152, v54
v_dot2c_f32_bf16 v26, v153, v53
v_dot2c_f32_bf16 v27, v153, v54
v_dot2c_f32_bf16 v28, v154, v53
v_dot2c_f32_bf16 v29, v154, v54
v_dot2c_f32_bf16 v30, v155, v53
v_dot2c_f32_bf16 v31, v155, v54
v_dot2c_f32_bf16 v32, v156, v53
v_dot2c_f32_bf16 v33, v156, v54
v_dot2c_f32_bf16 v34, v157, v53
v_dot2c_f32_bf16 v35, v157, v54
v_dot2c_f32_bf16 v36, v158, v53
v_dot2c_f32_bf16 v37, v158, v54
v_dot2c_f32_bf16 v38, v159, v53
v_dot2c_f32_bf16 v39, v159, v54
L_tail:
v_permlane32_swap_b32 v16, v28
v_permlane32_swap_b32 v17, v29
v_permlane32_swap_b32 v18, v30
v_permlane32_swap_b32 v19, v31
v_permlane32_swap_b32 v20, v32
v_permlane32_swap_b32 v21, v33
v_permlane32_swap_b32 v22, v34
v_permlane32_swap_b32 v23, v35
v_permlane32_swap_b32 v24, v36
v_permlane32_swap_b32 v25, v37
v_permlane32_swap_b32 v26, v38
v_permlane32_swap_b32 v27, v39
v_add_f32 v16, v16, v28
v_add_f32 v17, v17, v29
v_add_f32 v18, v18, v30
v_add_f32 v19, v19, v31
v_add_f32 v20, v20, v32
v_add_f32 v21, v21, v33
v_add_f32 v22, v22, v34
v_add_f32 v23, v23, v35
v_add_f32 v24, v24, v36
v_add_f32 v25, v25, v37
v_add_f32 v26, v26, v38
v_add_f32 v27, v27, v39
v_permlane16_swap_b32 v16, v22
v_permlane16_swap_b32 v17, v23
v_permlane16_swap_b32 v18, v24
v_permlane16_swap_b32 v19, v25
v_permlane16_swap_b32 v20, v26
v_permlane16_swap_b32 v21, v27
v_add_f32 v16, v16, v22
v_add_f32 v17, v17, v23
v_add_f32 v18, v18, v24
v_add_f32 v19, v19, v25
v_add_f32 v20, v20, v26
v_add_f32 v21, v21, v27
v_add_f32_dpp v16, v16, v16 row_ror:8 row_mask:0xf bank_mask:0x3
v_add_f32_dpp v17, v17, v17 row_ror:8 row_mask:0xf bank_mask:0x3
v_add_f32_dpp v18, v18, v18 row_ror:8 row_mask:0xf bank_mask:0x3
v_add_f32_dpp v16, v19, v19 row_ror:8 row_mask:0xf bank_mask:0xc
v_add_f32_dpp v17, v20, v20 row_ror:8 row_mask:0xf bank_mask:0xc
v_add_f32_dpp v18, v21, v21 row_ror:8 row_mask:0xf bank_mask:0xc
ds_write_b96 v6, v[16:18] offset:5120
s_waitcnt lgkmcnt(0)
v_mov_b32 v95, 3
s_mov_b64 exec, 1
ds_write_b32 v10, v95
s_mov_b64 exec, -1
s_waitcnt vmcnt(9)
v_perm_b32 v232, v188, v184, s82
v_perm_b32 v233, v188, v184, s83
v_perm_b32 v234, v189, v185, s82
v_perm_b32 v235, v189, v185, s83
v_perm_b32 v236, v190, v186, s82
v_perm_b32 v237, v190, v186, s83
v_perm_b32 v238, v191, v187, s82
v_perm_b32 v239, v191, v187, s83
s_waitcnt vmcnt(6)
v_perm_b32 v240, v196, v192, s82
v_perm_b32 v241, v196, v192, s83
v_perm_b32 v242, v197, v193, s82
v_perm_b32 v243, v197, v193, s83
v_perm_b32 v244, v198, v194, s82
v_perm_b32 v245, v198, v194, s83
v_perm_b32 v246, v199, v195, s82
v_perm_b32 v247, v199, v195, s83
v_perm_b32 v248, v204, v200, s82
v_perm_b32 v249, v204, v200, s83
v_perm_b32 v250, v205, v201, s82
v_perm_b32 v251, v205, v201, s83
v_perm_b32 v252, v206, v202, s82
v_perm_b32 v253, v206, v202, s83
v_perm_b32 v254, v207, v203, s82
v_perm_b32 v255, v207, v203, s83
s_waitcnt vmcnt(3)
v_perm_b32 v112, v212, v208, s82
v_perm_b32 v113, v212, v208, s83
v_perm_b32 v114, v213, v209, s82
v_perm_b32 v115, v213, v209, s83
v_perm_b32 v116, v214, v210, s82
v_perm_b32 v117, v214, v210, s83
v_perm_b32 v118, v215, v211, s82
v_perm_b32 v119, v215, v211, s83
s_waitcnt vmcnt(0)
v_perm_b32 v120, v220, v216, s82
v_perm_b32 v121, v220, v216, s83
v_perm_b32 v122, v221, v217, s82
v_perm_b32 v123, v221, v217, s83
v_perm_b32 v124, v222, v218, s82
v_perm_b32 v125, v222, v218, s83
v_perm_b32 v126, v223, v219, s82
v_perm_b32 v127, v223, v219, s83
v_perm_b32 v128, v228, v224, s82
v_perm_b32 v129, v228, v224, s83
v_perm_b32 v130, v229, v225, s82
v_perm_b32 v131, v229, v225, s83
v_perm_b32 v132, v230, v226, s82
v_perm_b32 v133, v230, v226, s83
v_perm_b32 v134, v231, v227, s82
v_perm_b32 v135, v231, v227, s83
s_waitcnt lgkmcnt(0)
s_add_u32 s32, s32, 0x9e3779b9
v_mov_b32 v11, s32
s_barrier
ds_read_b128 v[96:99], v8
ds_read_b64 v[100:101], v8 offset:16
s_waitcnt lgkmcnt(0)
v_dot2c_f32_bf16 v104, v232, v96
v_dot2c_f32_bf16 v105, v233, v96
v_dot2c_f32_bf16 v106, v234, v96
v_dot2c_f32_bf16 v107, v235, v96
v_dot2c_f32_bf16 v108, v236, v96
v_dot2c_f32_bf16 v109, v237, v96
v_dot2c_f32_bf16 v110, v238, v96
v_dot2c_f32_bf16 v111, v239, v96
v_dot2c_f32_bf16 v104, v240, v97
v_dot2c_f32_bf16 v105, v241, v97
v_dot2c_f32_bf16 v106, v242, v97
v_dot2c_f32_bf16 v107, v243, v97
v_dot2c_f32_bf16 v108, v244, v97
v_dot2c_f32_bf16 v109, v245, v97
v_dot2c_f32_bf16 v110, v246, v97
v_dot2c_f32_bf16 v111, v247, v97
v_dot2c_f32_bf16 v104, v248, v98
v_dot2c_f32_bf16 v105, v249, v98
v_dot2c_f32_bf16 v106, v250, v98
v_dot2c_f32_bf16 v107, v251, v98
v_dot2c_f32_bf16 v108, v252, v98
v_dot2c_f32_bf16 v109, v253, v98
v_dot2c_f32_bf16 v110, v254, v98
v_dot2c_f32_bf16 v111, v255, v98
v_dot2c_f32_bf16 v104, v112, v99
v_dot2c_f32_bf16 v105, v113, v99
v_dot2c_f32_bf16 v106, v114, v99
v_dot2c_f32_bf16 v107, v115, v99
v_dot2c_f32_bf16 v108, v116, v99
v_dot2c_f32_bf16 v109, v117, v99
v_dot2c_f32_bf16 v110, v118, v99
v_dot2c_f32_bf16 v111, v119, v99
v_dot2c_f32_bf16 v104, v120, v100
v_dot2c_f32_bf16 v105, v121, v100
v_dot2c_f32_bf16 v106, v122, v100
v_dot2c_f32_bf16 v107, v123, v100
v_dot2c_f32_bf16 v108, v124, v100
v_dot2c_f32_bf16 v109, v125, v100
v_dot2c_f32_bf16 v110, v126, v100
v_dot2c_f32_bf16 v111, v127, v100
v_dot2c_f32_bf16 v104, v128, v101
v_dot2c_f32_bf16 v105, v129, v101
v_dot2c_f32_bf16 v106, v130, v101
v_dot2c_f32_bf16 v107, v131, v101
v_dot2c_f32_bf16 v108, v132, v101
v_dot2c_f32_bf16 v109, v133, v101
v_dot2c_f32_bf16 v110, v134, v101
v_dot2c_f32_bf16 v111, v135, v101
v_permlane32_swap_b32 v104, v108
v_permlane32_swap_b32 v105, v109
v_permlane32_swap_b32 v106, v110
v_permlane32_swap_b32 v107, v111
v_add_f32 v104, v104, v108
v_add_f32 v105, v105, v109
v_add_f32 v106, v106, v110
v_add_f32 v107, v107, v111
v_mov_b32 v108, v104
v_mov_b32 v109, v105
v_mov_b32 v110, v106
v_mov_b32 v111, v107
v_permlane16_swap_b32 v104, v108
v_permlane16_swap_b32 v105, v109
v_permlane16_swap_b32 v106, v110
v_permlane16_swap_b32 v107, v111
v_add_f32 v104, v104, v108
v_add_f32 v105, v105, v109
v_add_f32 v106, v106, v110
v_add_f32 v107, v107, v111
v_add_f32_dpp v104, v104, v104 row_ror:8 row_mask:0xf bank_mask:0xf
v_add_f32_dpp v105, v105, v105 row_ror:8 row_mask:0xf bank_mask:0xf
v_add_f32_dpp v106, v106, v106 row_ror:8 row_mask:0xf bank_mask:0xf
v_add_f32_dpp v107, v107, v107 row_ror:8 row_mask:0xf bank_mask:0xf
v_perm_b32 v108, v104, v11, s84
v_perm_b32 v109, v105, v11, s85
v_perm_b32 v110, v106, v11, s86
v_perm_b32 v111, v107, v11, s87
s_mov_b32 exec_lo, 0xff
s_mov_b32 exec_hi, 0xff
buffer_store_dwordx4 v[108:111], v5, s[60:63], 0 offen sc1
s_mov_b64 exec, -1
s_endpgm
L_tC2:
s_branch L_tC_ret
L_agent3:
s_lshl_b32 s39, s34, 8
s_add_u32 s39, s39, 266240
s_lshl_b32 s76, s35, 4
s_add_u32 s76, s76, s39
v_and_b32 v10, 1, v0
v_lshlrev_b32 v10, 7, v10
v_add_u32 v10, s76, v10
s_lshl_b32 s76, s38, 7
s_add_u32 s39, s39, s76
v_lshrrev_b32 v13, 5, v0
v_lshlrev_b32 v15, 4, v13
v_add_u32 v15, s39, v15
v_mov_b32 v11, 0
s_mov_b32 s88, 262144
L_a_ml:
ds_read_b32 v32, v2
s_waitcnt lgkmcnt(0)
v_cmp_le_u32 vcc, 2, v32
s_cmp_eq_u64 vcc, -1
s_cbranch_scc1 L_a_ml_ok
s_sub_u32 s88, s88, 1
s_cbranch_scc0 L_a_ml
L_a_ml_ok:
ds_read_b64 v[22:23], v11 offset:11264
ds_read_b64 v[24:25], v11 offset:11272
ds_read_b64 v[26:27], v11 offset:11280
ds_read_b64 v[28:29], v11 offset:11288
ds_read_b64 v[30:31], v11 offset:11296
s_waitcnt lgkmcnt(0)
v_max3_f32 v32, v24, v26, v28
v_max_f32 v32, v32, v30
v_sub_f32 v17, v24, v32
v_sub_f32 v18, v26, v32
v_sub_f32 v19, v28, v32
v_sub_f32 v20, v30, v32
v_mul_f32 v17, s81, v17
v_mul_f32 v18, s81, v18
v_mul_f32 v19, s81, v19
v_mul_f32 v20, s81, v20
v_exp_f32 v17, v17
v_exp_f32 v18, v18
v_exp_f32 v19, v19
v_exp_f32 v20, v20
v_mul_f32 v33, v17, v25
v_fma_f32 v33, v18, v27, v33
v_fma_f32 v33, v19, v29, v33
v_fma_f32 v33, v20, v31, v33
v_cmp_eq_u32 vcc, 0, v0
s_nop 1
v_cndmask_b32 v40, v32, v22, vcc
v_cndmask_b32 v41, v33, v23, vcc
v_mov_b32 v42, 0
v_mov_b32 v43, v1
s_mov_b64 exec, 3
buffer_store_dwordx4 v[40:43], v10, s[60:63], 0 offen sc1
s_mov_b64 exec, -1
v_lshlrev_b32 v8, 4, v0
v_and_b32 v12, 31, v0
v_lshlrev_b32 v12, 4, v12
s_lshl_b32 s39, s34, 14
s_add_u32 s39, s39, 278528
s_lshl_b32 s76, s35, 9
s_add_u32 s76, s76, s39
v_lshlrev_b32 v9, 12, v13
v_add_u32 v9, v9, v12
v_add_u32 v9, s76, v9
v_add_u32 v10, 0x2000, v9
s_lshl_b32 s76, s38, 13
s_add_u32 s39, s39, s76
s_lshl_b32 s76, s37, 12
s_add_u32 s39, s39, s76
v_lshlrev_b32 v11, 9, v13
v_add_u32 v11, v11, v12
v_add_u32 v11, s39, v11
v_and_b32 v14, 3, v6
v_mul_u32_u24 v14, 6, v14
v_lshlrev_b32 v12, 5, v7
v_add_u32 v14, v14, v12
s_mov_b32 s88, 262144
L_a_o:
ds_read_b32 v32, v2
s_waitcnt lgkmcnt(0)
v_cmp_le_u32 vcc, 3, v32
s_cmp_eq_u64 vcc, -1
s_cbranch_scc1 L_a_o_ok
s_sub_u32 s88, s88, 1
s_cbranch_scc0 L_a_o
L_a_o_ok:
ds_read_b96 v[32:34], v8 offset:5120
ds_read_b96 v[36:38], v8 offset:6144
ds_read_b96 v[40:42], v8 offset:7168
ds_read_b96 v[44:46], v8 offset:8192
ds_read_b96 v[48:50], v8 offset:9216
s_waitcnt lgkmcnt(0)
v_mov_b32 v35, v1
buffer_store_dwordx4 v[32:35], v9, s[60:63], 0 offen sc1
v_mul_f32 v56, v17, v36
v_mul_f32 v57, v17, v37
v_mul_f32 v58, v17, v38
v_mov_b32 v59, v1
v_fma_f32 v56, v18, v40, v56
v_fma_f32 v57, v18, v41, v57
v_fma_f32 v58, v18, v42, v58
v_fma_f32 v56, v19, v44, v56
v_fma_f32 v57, v19, v45, v57
v_fma_f32 v58, v19, v46, v58
v_fma_f32 v56, v20, v48, v56
v_fma_f32 v57, v20, v49, v57
v_fma_f32 v58, v20, v50, v58
buffer_store_dwordx4 v[56:59], v10, s[60:63], 0 offen sc1
s_mov_b32 s88, 32768
buffer_load_dwordx4 v[64:67], v11, s[60:63], 0 offen offset:0 sc1
buffer_load_dwordx4 v[68:71], v11, s[60:63], 0 offen offset:1024 sc1
buffer_load_dwordx4 v[72:75], v11, s[60:63], 0 offen offset:2048 sc1
buffer_load_dwordx4 v[76:79], v11, s[60:63], 0 offen offset:3072 sc1
buffer_load_dwordx4 v[80:83], v15, s[60:63], 0 offen offset:0 sc1
buffer_load_dwordx4 v[84:87], v15, s[60:63], 0 offen offset:32 sc1
buffer_load_dwordx4 v[88:91], v15, s[60:63], 0 offen offset:64 sc1
buffer_load_dwordx4 v[92:95], v15, s[60:63], 0 offen offset:96 sc1
s_branch L_a_x2o_w
L_a_x2o:
s_mov_b64 exec, s[4:5]
buffer_load_dwordx4 v[64:67], v11, s[60:63], 0 offen offset:0 sc1
s_mov_b64 exec, s[6:7]
buffer_load_dwordx4 v[68:71], v11, s[60:63], 0 offen offset:1024 sc1
s_mov_b64 exec, s[8:9]
buffer_load_dwordx4 v[72:75], v11, s[60:63], 0 offen offset:2048 sc1
s_mov_b64 exec, s[10:11]
buffer_load_dwordx4 v[76:79], v11, s[60:63], 0 offen offset:3072 sc1
s_mov_b64 exec, s[12:13]
buffer_load_dwordx4 v[80:83], v15, s[60:63], 0 offen offset:0 sc1
s_mov_b64 exec, s[14:15]
buffer_load_dwordx4 v[84:87], v15, s[60:63], 0 offen offset:32 sc1
s_mov_b64 exec, s[16:17]
buffer_load_dwordx4 v[88:91], v15, s[60:63], 0 offen offset:64 sc1
s_mov_b64 exec, s[18:19]
buffer_load_dwordx4 v[92:95], v15, s[60:63], 0 offen offset:96 sc1
s_mov_b64 exec, -1
s_sub_u32 s88, s88, 1
s_cbranch_scc1 L_a_x2o_ok
L_a_x2o_w:
s_waitcnt vmcnt(0)
v_cmp_ne_u32_e64 s[4:5], v67, v1
v_cmp_ne_u32_e64 s[6:7], v71, v1
v_cmp_ne_u32_e64 s[8:9], v75, v1
v_cmp_ne_u32_e64 s[10:11], v79, v1
v_cmp_ne_u32_e64 s[12:13], v83, v1
v_cmp_ne_u32_e64 s[14:15], v87, v1
v_cmp_ne_u32_e64 s[16:17], v91, v1
v_cmp_ne_u32_e64 s[18:19], v95, v1
s_or_b64 s[78:79], s[4:5], s[6:7]
s_or_b64 s[78:79], s[78:79], s[8:9]
s_or_b64 s[78:79], s[78:79], s[10:11]
s_or_b64 s[78:79], s[78:79], s[12:13]
s_or_b64 s[78:79], s[78:79], s[14:15]
s_or_b64 s[78:79], s[78:79], s[16:17]
s_or_b64 s[78:79], s[78:79], s[18:19]
s_cbranch_scc1 L_a_x2o
L_a_x2o_ok:
v_max3_f32 v32, v80, v84, v88
v_max_f32 v32, v32, v92
v_mov_b32 v33, v32
s_nop 1
v_permlane32_swap_b32 v32, v33
v_max_f32 v32, v32, v33
v_sub_f32 v80, v80, v32
v_sub_f32 v84, v84, v32
v_sub_f32 v88, v88, v32
v_sub_f32 v92, v92, v32
v_mul_f32 v80, s81, v80
v_mul_f32 v84, s81, v84
v_mul_f32 v88, s81, v88
v_mul_f32 v92, s81, v92
v_exp_f32 v80, v80
v_exp_f32 v84, v84
v_exp_f32 v88, v88
v_exp_f32 v92, v92
v_mul_f32 v67, v80, v81
v_mul_f32 v64, v80, v64
v_mul_f32 v65, v80, v65
v_mul_f32 v66, v80, v66
v_fma_f32 v67, v84, v85, v67
v_fma_f32 v64, v84, v68, v64
v_fma_f32 v65, v84, v69, v65
v_fma_f32 v66, v84, v70, v66
v_fma_f32 v67, v88, v89, v67
v_fma_f32 v64, v88, v72, v64
v_fma_f32 v65, v88, v73, v65
v_fma_f32 v66, v88, v74, v66
v_fma_f32 v67, v92, v93, v67
v_fma_f32 v64, v92, v76, v64
v_fma_f32 v65, v92, v77, v65
v_fma_f32 v66, v92, v78, v66
v_mov_b32 v71, v67
v_mov_b32 v68, v64
v_mov_b32 v69, v65
v_mov_b32 v70, v66
v_permlane32_swap_b32 v67, v71
v_permlane32_swap_b32 v64, v68
v_permlane32_swap_b32 v65, v69
v_permlane32_swap_b32 v66, v70
v_add_f32 v67, v67, v71
v_add_f32 v64, v64, v68
v_add_f32 v65, v65, v69
v_add_f32 v66, v66, v70
v_rcp_f32 v67, v67
s_nop 0
v_mul_f32 v64, v67, v64
v_mul_f32 v65, v67, v65
v_mul_f32 v66, v67, v66
v_cvt_pk_bf16_f32 v32, v64, v65
v_cvt_pk_bf16_f32 v33, v66, v66
s_mov_b32 exec_hi, 0
ds_write_b16 v14, v32 offset:11008
ds_write_b16_d16_hi v14, v32 offset:11010
ds_write_b16 v14, v33 offset:11012
s_mov_b64 exec, -1
s_waitcnt lgkmcnt(0)
s_barrier
s_lshr_b32 s39, s2, 6
s_lshl_b32 s39, s39, 3
s_and_b32 s76, s2, 7
s_add_u32 s39, s39, s76
s_cmp_ge_u32 s39, 20
s_cbranch_scc1 L_a_done
s_lshr_b32 s76, s2, 3
s_and_b32 s76, s76, 7
s_lshl_b32 s39, s39, 5
s_lshl_b32 s76, s76, 2
s_add_u32 s39, s39, s76
s_lshl_b32 s76, s39, 2
s_add_u32 s76, s76, 802816
v_mul_u32_u24 v8, 2560, v0
v_add_u32 v8, s76, v8
v_add_u32 v9, 163840, v8
s_lshl_b32 s39, s39, 1
v_lshrrev_b32 v10, 4, v0
v_lshlrev_b32 v10, 2, v10
v_add_u32 v10, s39, v10
v_cmp_gt_u32 vcc, 32, v0
s_nop 1
v_cndmask_b32 v11, v5, v4, vcc
s_mov_b32 s80, 0x0c0c0400
s_mov_b32 s82, 0x04000c0c
s_mov_b32 s88, 32768
buffer_load_dwordx4 v[64:67], v8, s[60:63], 0 offen sc1
buffer_load_dwordx4 v[68:71], v9, s[60:63], 0 offen sc1
s_branch L_a_x3_w
L_a_x3:
s_mov_b64 exec, s[4:5]
buffer_load_dwordx4 v[64:67], v8, s[60:63], 0 offen sc1
s_mov_b64 exec, s[6:7]
buffer_load_dwordx4 v[68:71], v9, s[60:63], 0 offen sc1
s_mov_b64 exec, -1
s_sub_u32 s88, s88, 1
s_cbranch_scc1 L_a_x3_ok
L_a_x3_w:
s_waitcnt vmcnt(0)
v_perm_b32 v32, v65, v64, s80
v_perm_b32 v33, v67, v66, s82
v_or_b32 v32, v32, v33
v_cmp_ne_u32_e64 s[4:5], v32, v1
v_perm_b32 v32, v69, v68, s80
v_perm_b32 v33, v71, v70, s82
v_or_b32 v32, v32, v33
v_cmp_ne_u32_e64 s[6:7], v32, v1
s_or_b64 s[78:79], s[4:5], s[6:7]
s_cbranch_scc1 L_a_x3
L_a_x3_ok:
v_permlane32_swap_b32 v64, v68
v_permlane32_swap_b32 v65, v69
v_permlane32_swap_b32 v66, v70
v_permlane32_swap_b32 v67, v71
v_add_f32 v64, v64, v68
v_add_f32 v65, v65, v69
v_add_f32 v66, v66, v70
v_add_f32 v67, v67, v71
s_nop 0
v_permlane16_swap_b32 v64, v66
v_permlane16_swap_b32 v65, v67
v_add_f32 v64, v64, v66
v_add_f32 v65, v65, v67
s_nop 0
v_add_f32_dpp v64, v64, v64 row_ror:8 row_mask:0xf bank_mask:0xf
v_add_f32_dpp v65, v65, v65 row_ror:8 row_mask:0xf bank_mask:0xf
s_nop 0
v_add_f32_dpp v64, v64, v64 row_ror:4 row_mask:0xf bank_mask:0xf
v_add_f32_dpp v65, v65, v65 row_ror:4 row_mask:0xf bank_mask:0xf
s_nop 0
v_add_f32_dpp v64, v64, v64 row_ror:2 row_mask:0xf bank_mask:0xf
v_add_f32_dpp v65, v65, v65 row_ror:2 row_mask:0xf bank_mask:0xf
s_nop 0
v_add_f32_dpp v64, v64, v64 row_ror:1 row_mask:0xf bank_mask:0xf
v_add_f32_dpp v65, v65, v65 row_ror:1 row_mask:0xf bank_mask:0xf
v_cvt_pk_bf16_f32 v64, 0, v64
v_cvt_pk_bf16_f32 v65, 0, v65
v_mul_f32 v64, v11, v64
v_mul_f32 v65, v11, v65
v_cvt_pk_bf16_f32 v64, 0, v64
v_cvt_pk_bf16_f32 v65, 0, v65
v_mov_b32 v66, v64
v_mov_b32 v67, v65
s_nop 0
v_permlane32_swap_b32 v64, v66
v_permlane32_swap_b32 v65, v67
v_add_f32 v64, v64, v66
v_add_f32 v65, v65, v67
v_cvt_pk_bf16_f32 v64, v64, v65
s_mov_b32 exec_lo, 0x00010001
s_mov_b32 exec_hi, 0
buffer_store_dword v64, v10, s[44:47], 0 offen
s_mov_b64 exec, -1
s_cmp_lg_u32 s2, 0
s_cbranch_scc1 L_a_done
v_mov_b32 v12, 0
s_mov_b64 exec, 1
buffer_store_dword v1, v12, s[60:63], 0 offen sc1
s_mov_b64 exec, -1
L_a_done:
L_end:
s_endpgm
.p2align 12
L_agent2:
v_lshlrev_b32 v8, 4, v0
s_lshl_b32 s39, s34, 13
s_add_u32 s39, s39, 4096
v_add_u32 v9, s39, v8
v_add_u32 v10, 0x1000, v9
s_lshl_b32 s76, s35, 10
v_add_u32 v11, s76, v9
s_mov_b32 s88, 262144
L_a_q:
ds_read_b32 v32, v2
s_waitcnt lgkmcnt(0)
v_cmp_le_u32 vcc, 1, v32
s_cmp_eq_u64 vcc, -1
s_cbranch_scc1 L_a_q_ok
s_sub_u32 s88, s88, 1
s_cbranch_scc0 L_a_q
L_a_q_ok:
ds_read_b96 v[32:34], v8 offset:0
ds_read_b96 v[36:38], v8 offset:1024
ds_read_b96 v[40:42], v8 offset:2048
ds_read_b96 v[44:46], v8 offset:3072
ds_read_b96 v[48:50], v8 offset:4096
s_waitcnt lgkmcnt(0)
v_add_f32 v32, v32, v36
v_add_f32 v40, v40, v44
v_add_f32 v33, v33, v37
v_add_f32 v41, v41, v45
v_add_f32 v34, v34, v38
v_add_f32 v42, v42, v46
v_add_f32 v32, v32, v48
v_add_f32 v33, v33, v49
v_add_f32 v34, v34, v50
v_add_f32 v32, v32, v40
v_add_f32 v33, v33, v41
v_add_f32 v34, v34, v42
v_mov_b32 v35, v1
buffer_store_dwordx4 v[32:35], v11, s[60:63], 0 offen sc1
s_mov_b32 s88, 32768
L_a_x1:
buffer_load_dwordx4 v[64:67], v9, s[60:63], 0 offen offset:0 sc1
buffer_load_dwordx4 v[68:71], v9, s[60:63], 0 offen offset:1024 sc1
buffer_load_dwordx4 v[72:75], v9, s[60:63], 0 offen offset:2048 sc1
buffer_load_dwordx4 v[76:79], v9, s[60:63], 0 offen offset:3072 sc1
buffer_load_dwordx4 v[80:83], v10, s[60:63], 0 offen offset:0 sc1
buffer_load_dwordx4 v[84:87], v10, s[60:63], 0 offen offset:1024 sc1
buffer_load_dwordx4 v[88:91], v10, s[60:63], 0 offen offset:2048 sc1
buffer_load_dwordx4 v[92:95], v10, s[60:63], 0 offen offset:3072 sc1
s_waitcnt vmcnt(0)
s_mov_b64 s[78:79], -1
v_cmp_eq_u32 vcc, v67, v1
s_and_b64 s[78:79], s[78:79], vcc
v_cmp_eq_u32 vcc, v71, v1
s_and_b64 s[78:79], s[78:79], vcc
v_cmp_eq_u32 vcc, v75, v1
s_and_b64 s[78:79], s[78:79], vcc
v_cmp_eq_u32 vcc, v79, v1
s_and_b64 s[78:79], s[78:79], vcc
v_cmp_eq_u32 vcc, v83, v1
s_and_b64 s[78:79], s[78:79], vcc
v_cmp_eq_u32 vcc, v87, v1
s_and_b64 s[78:79], s[78:79], vcc
v_cmp_eq_u32 vcc, v91, v1
s_and_b64 s[78:79], s[78:79], vcc
v_cmp_eq_u32 vcc, v95, v1
s_and_b64 s[78:79], s[78:79], vcc
s_cmp_eq_u64 s[78:79], -1
s_cbranch_scc1 L_a_x1_ok
s_sub_u32 s88, s88, 1
s_cbranch_scc0 L_a_x1
L_a_x1_ok:
v_add_f32 v64, v64, v68
v_add_f32 v72, v72, v76
v_add_f32 v65, v65, v69
v_add_f32 v73, v73, v77
v_add_f32 v66, v66, v70
v_add_f32 v74, v74, v78
v_add_f32 v64, v64, v72
v_add_f32 v65, v65, v73
v_add_f32 v66, v66, v74
v_add_f32 v80, v80, v84
v_add_f32 v88, v88, v92
v_add_f32 v81, v81, v85
v_add_f32 v89, v89, v93
v_add_f32 v82, v82, v86
v_add_f32 v90, v90, v94
v_add_f32 v80, v80, v88
v_add_f32 v81, v81, v89
v_add_f32 v82, v82, v90
v_mul_u32_u24 v12, 48, v7
v_mul_u32_u24 v13, 6, v6
v_add_u32 v12, v12, v13
v_cvt_pk_bf16_f32 v32, v64, v65
v_cvt_pk_bf16_f32 v33, v66, v66
v_cvt_pk_bf16_f32 v34, v80, v81
v_cvt_pk_bf16_f32 v35, v82, v82
ds_write_b16 v12, v32 offset:10240
ds_write_b16_d16_hi v12, v32 offset:10242
ds_write_b16 v12, v33 offset:10244
ds_write_b16 v12, v34 offset:10624
ds_write_b16_d16_hi v12, v34 offset:10626
ds_write_b16 v12, v35 offset:10628
v_mov_b32 v12, 11392
v_mov_b32 v32, 1
s_mov_b64 exec, 1
ds_write_b32 v12, v32
s_mov_b64 exec, -1
s_branch L_tC0
L_tC_ret:
s_branch L_agent3
.section .rodata,"a"
.p2align 6
.amdhsa_kernel gated_mix__sliding_block_cached__gqa_block_cached__decode_kernel
  .amdhsa_next_free_vgpr 256
  .amdhsa_next_free_sgpr 102
  .amdhsa_accum_offset 256
  .amdhsa_group_segment_fixed_size 0
  .amdhsa_kernarg_size 112
  .amdhsa_user_sgpr_count 2
  .amdhsa_user_sgpr_kernarg_segment_ptr 1
  .amdhsa_system_sgpr_workgroup_id_x 1
.end_amdhsa_kernel
```
